```python
import torch

def _softmax(x, axis=-1):
    return torch.softmax(x, dim=axis)
def _gelu(x):
    return torch.nn.functional.gelu(x, approximate="tanh")
def _silu(x):
    return torch.nn.functional.silu(x)
def _sigmoid(x):
    return torch.sigmoid(x)
def _layernorm(x, axis=-1, eps=1e-5):
    m = x.mean(dim=axis, keepdim=True)
    v = x.var(dim=axis, keepdim=True, unbiased=False)
    return (x - m) / torch.sqrt(v + eps)
def _scatter_add(tgt, idx, src, axis=0):
    return tgt.clone().index_add_(axis, idx, src)
def _segment_sum(src, seg, n):
    out = torch.zeros((n,) + src.shape[1:], dtype=src.dtype)
    return out.index_add_(0, seg, src)
def _pad(x, pw):
    flat = tuple(v for pair in reversed(pw) for v in pair)
    return torch.nn.functional.pad(x, flat)

kernel_name = 'parallel_sum__spectral_gfnet__mixer_token_mlp__prompt'

def setup_inputs():

    _w = (lambda a: (lambda t: t.to(torch.bfloat16) if t.is_floating_point() else t)(torch.as_tensor(a)))
    def _A_setup():
        B, S, D = 1, 2048, 576
        Df = D // 2 + 1
        return {
            "x": _w((lambda *s: torch.randn(*s, dtype=torch.bfloat16) * 0.05)(B, S, D)),
            "w_r": _w((lambda *s: torch.randn(*s, dtype=torch.bfloat16) * 3.2)(S, Df) * 0.02),
            "w_i": _w((lambda *s: torch.randn(*s, dtype=torch.bfloat16) * 3.2)(S, Df) * 0.02),
        }
    _A_in = _A_setup()

    def _B_setup():
        B, S, D, F = 1, 2048, 576, 4608
        return {
            "x": _w((lambda *s: torch.randn(*s, dtype=torch.bfloat16) * 0.05)(B, S, D)),
            "w1": _w((lambda *s: torch.randn(*s, dtype=torch.bfloat16) * 0.4)(S, F) * (S ** -0.5)),
            "b1": _w((lambda *s: torch.randn(*s, dtype=torch.bfloat16) * 3.2)(F) * 0.02),
            "w2": _w((lambda *s: torch.randn(*s, dtype=torch.bfloat16) * 0.8)(F, S) * (F ** -0.5)),
            "b2": _w((lambda *s: torch.randn(*s, dtype=torch.bfloat16) * 3.2)(S) * 0.02),
        }
    _B_in = _B_setup()

    return {
        "A_x": _A_in["x"],
        "A_w_r": _A_in["w_r"],
        "A_w_i": _A_in["w_i"],
        "B_x": _B_in["x"],
        "B_w1": _B_in["w1"],
        "B_b1": _B_in["b1"],
        "B_w2": _B_in["w2"],
        "B_b2": _B_in["b2"],
    }

def reference(A_x, A_w_r, A_w_i, B_x, B_w1, B_b1, B_w2, B_b2):
    def _A_ref(x, w_r, w_i):
        B, S, D = x.shape
        X = (lambda x, axes=(-2,-1): torch.fft.rfft2(x.float(), dim=axes))(x, axes=(-2, -1))
        W = w_r + 1j * w_i
        X = X * W
        y = (lambda x, s, axes=(-2,-1): torch.fft.irfft2(x, s=s, dim=axes).to(torch.bfloat16))(X, (S, D), axes=(-2, -1))
        return y

    def _B_ref(x, w1, b1, w2, b2):
        B, S, D = x.shape
        h = _layernorm(x, axis=-1)
        u = torch.einsum("bsd,sf->bdf", h, w1) + b1
        u = _gelu(u)
        y = torch.einsum("bdf,fs->bds", u, w2) + b2
        return (lambda x, *d: x.permute(*d))(y, 0, 2, 1)

    x = A_x
    xn = _layernorm(x, axis=-1)
    return x + _A_ref(xn, A_w_r, A_w_i) + _B_ref(xn, B_w1, B_b1, B_w2, B_b2)
```

```asm
; @launch grid=(256,1,1) block=(512,1,1) lds=156672
.amdgcn_target "amdgcn-amd-amdhsa--gfx950"
.text
.globl parallel_sum__spectral_gfnet__mixer_token_mlp__prompt_kernel
.p2align 8
.type parallel_sum__spectral_gfnet__mixer_token_mlp__prompt_kernel,@function
parallel_sum__spectral_gfnet__mixer_token_mlp__prompt_kernel:
    s_cmp_ge_u32 s2, 256
    s_cbranch_scc1 L_k2_end
    s_load_dwordx2 s[8:9], s[0:1], 80
    v_lshrrev_b32 v1, 6, v0
    v_and_b32 v2, 63, v0
    s_nop 0
    v_readfirstlane_b32 s33, v1
    s_waitcnt lgkmcnt(0)
    s_add_u32 s56, s8, 83886080
    s_addc_u32 s57, s9, 0
    s_mov_b32 s58, 98304
    s_mov_b32 s59, 0x00020000
    s_load_dwordx2 s[4:5], s[0:1], 0
    s_load_dwordx4 s[36:39], s[0:1], 8
    s_load_dwordx2 s[40:41], s[0:1], 32
    s_load_dwordx2 s[42:43], s[0:1], 72
    s_cmp_ge_u32 s33, 5
    s_cbranch_scc1 L_a_aux
    v_mul_u32_u24 v3, 911, v0
    v_lshrrev_b32 v3, 16, v3
    v_mul_u32_u24 v4, 72, v3
    v_sub_u32 v4, v0, v4
    v_lshrrev_b32 v5, 3, v4
    v_and_b32 v6, 7, v4
    v_mul_u32_u24 v7, 5184, v3
    v_mul_u32_u24 v8, 576, v5
    v_add_u32 v7, v7, v8
    s_lshl_b32 s21, s2, 3
    s_lshl_b32 s22, s33, 1
    s_add_u32 s21, s21, s22
    s_mul_i32 s21, s21, 1152
    v_lshlrev_b32 v9, 1, v2
    s_waitcnt lgkmcnt(0)
    s_mov_b32 s12, s4
    s_mov_b32 s13, s5
    s_mov_b32 s14, 2359296
    s_mov_b32 s15, 0x00020000
    s_mov_b32 s16, s8
    s_mov_b32 s17, s9
    s_mov_b32 s18, 2359296
    s_mov_b32 s19, 0x00020000
    s_add_u32 s24, s8, 50331648
    s_addc_u32 s25, s9, 0
    s_mov_b32 s26, 4751360
    s_mov_b32 s27, 0x00020000
    s_cmp_ge_u32 s33, 4
    s_cbranch_scc1 L_a_skipln
    buffer_load_ushort v10, v9, s[12:15], s21 offen offset:0
    buffer_load_ushort v20, v9, s[12:15], s21 offen offset:1152
    buffer_load_ushort v11, v9, s[12:15], s21 offen offset:128
    buffer_load_ushort v21, v9, s[12:15], s21 offen offset:1280
    buffer_load_ushort v12, v9, s[12:15], s21 offen offset:256
    buffer_load_ushort v22, v9, s[12:15], s21 offen offset:1408
    buffer_load_ushort v13, v9, s[12:15], s21 offen offset:384
    buffer_load_ushort v23, v9, s[12:15], s21 offen offset:1536
    buffer_load_ushort v14, v9, s[12:15], s21 offen offset:512
    buffer_load_ushort v24, v9, s[12:15], s21 offen offset:1664
    buffer_load_ushort v15, v9, s[12:15], s21 offen offset:640
    buffer_load_ushort v25, v9, s[12:15], s21 offen offset:1792
    buffer_load_ushort v16, v9, s[12:15], s21 offen offset:768
    buffer_load_ushort v26, v9, s[12:15], s21 offen offset:1920
    buffer_load_ushort v17, v9, s[12:15], s21 offen offset:896
    buffer_load_ushort v27, v9, s[12:15], s21 offen offset:2048
    buffer_load_ushort v18, v9, s[12:15], s21 offen offset:1024
    buffer_load_ushort v28, v9, s[12:15], s21 offen offset:2176
    v_cvt_f32_u32 v60, v2
    v_mul_f32 v61, 0xbae38e39, v60
    v_cos_f32 v82, v61
    v_sin_f32 v83, v61
    v_mul_f32 v61, 0xbb638e39, v60
    v_cos_f32 v84, v61
    v_sin_f32 v85, v61
    v_mul_f32 v61, 0xbbaaaaab, v60
    v_cos_f32 v86, v61
    v_sin_f32 v87, v61
    v_mul_f32 v61, 0xbbe38e39, v60
    v_cos_f32 v88, v61
    v_sin_f32 v89, v61
    v_mul_f32 v61, 0xbc0e38e4, v60
    v_cos_f32 v90, v61
    v_sin_f32 v91, v61
    v_mul_f32 v61, 0xbc2aaaab, v60
    v_cos_f32 v92, v61
    v_sin_f32 v93, v61
    v_mul_f32 v61, 0xbc471c72, v60
    v_cos_f32 v94, v61
    v_sin_f32 v95, v61
    v_mul_f32 v61, 0xbc638e39, v60
    v_cos_f32 v96, v61
    v_sin_f32 v97, v61
    s_waitcnt vmcnt(0)
    v_lshlrev_b32 v10, 16, v10
    v_lshlrev_b32 v20, 16, v20
    v_lshlrev_b32 v11, 16, v11
    v_lshlrev_b32 v21, 16, v21
    v_lshlrev_b32 v12, 16, v12
    v_lshlrev_b32 v22, 16, v22
    v_lshlrev_b32 v13, 16, v13
    v_lshlrev_b32 v23, 16, v23
    v_lshlrev_b32 v14, 16, v14
    v_lshlrev_b32 v24, 16, v24
    v_lshlrev_b32 v15, 16, v15
    v_lshlrev_b32 v25, 16, v25
    v_lshlrev_b32 v16, 16, v16
    v_lshlrev_b32 v26, 16, v26
    v_lshlrev_b32 v17, 16, v17
    v_lshlrev_b32 v27, 16, v27
    v_lshlrev_b32 v18, 16, v18
    v_lshlrev_b32 v28, 16, v28
    v_add_f32 v60, v10, v11
    v_add_f32 v61, v20, v21
    v_add_f32 v60, v60, v12
    v_add_f32 v61, v61, v22
    v_add_f32 v60, v60, v13
    v_add_f32 v61, v61, v23
    v_add_f32 v60, v60, v14
    v_add_f32 v61, v61, v24
    v_add_f32 v60, v60, v15
    v_add_f32 v61, v61, v25
    v_add_f32 v60, v60, v16
    v_add_f32 v61, v61, v26
    v_add_f32 v60, v60, v17
    v_add_f32 v61, v61, v27
    v_add_f32 v60, v60, v18
    v_add_f32 v61, v61, v28
    s_nop 1
    v_add_f32_dpp v60, v60, v60 row_shr:1 row_mask:0xf bank_mask:0xf bound_ctrl:0
    v_add_f32_dpp v61, v61, v61 row_shr:1 row_mask:0xf bank_mask:0xf bound_ctrl:0
    s_nop 1
    v_add_f32_dpp v60, v60, v60 row_shr:2 row_mask:0xf bank_mask:0xf bound_ctrl:0
    v_add_f32_dpp v61, v61, v61 row_shr:2 row_mask:0xf bank_mask:0xf bound_ctrl:0
    s_nop 1
    v_add_f32_dpp v60, v60, v60 row_shr:4 row_mask:0xf bank_mask:0xf bound_ctrl:0
    v_add_f32_dpp v61, v61, v61 row_shr:4 row_mask:0xf bank_mask:0xf bound_ctrl:0
    s_nop 1
    v_add_f32_dpp v60, v60, v60 row_shr:8 row_mask:0xf bank_mask:0xf bound_ctrl:0
    v_add_f32_dpp v61, v61, v61 row_shr:8 row_mask:0xf bank_mask:0xf bound_ctrl:0
    s_nop 1
    v_add_f32_dpp v60, v60, v60 row_bcast:15 row_mask:0xa bank_mask:0xf
    v_add_f32_dpp v61, v61, v61 row_bcast:15 row_mask:0xa bank_mask:0xf
    s_nop 1
    v_add_f32_dpp v60, v60, v60 row_bcast:31 row_mask:0xc bank_mask:0xf
    v_add_f32_dpp v61, v61, v61 row_bcast:31 row_mask:0xc bank_mask:0xf
    s_nop 1
    v_readlane_b32 s44, v60, 63
    v_readlane_b32 s45, v61, 63
    s_nop 1
    v_mov_b32 v70, 0x3ae38e39
    v_mul_f32 v62, s44, v70
    v_mul_f32 v63, s45, v70
    v_sub_f32 v64, v10, v62
    v_sub_f32 v65, v20, v63
    v_mul_f32 v60, v64, v64
    v_mul_f32 v61, v65, v65
    v_sub_f32 v64, v11, v62
    v_sub_f32 v65, v21, v63
    v_fmac_f32 v60, v64, v64
    v_fmac_f32 v61, v65, v65
    v_sub_f32 v64, v12, v62
    v_sub_f32 v65, v22, v63
    v_fmac_f32 v60, v64, v64
    v_fmac_f32 v61, v65, v65
    v_sub_f32 v64, v13, v62
    v_sub_f32 v65, v23, v63
    v_fmac_f32 v60, v64, v64
    v_fmac_f32 v61, v65, v65
    v_sub_f32 v64, v14, v62
    v_sub_f32 v65, v24, v63
    v_fmac_f32 v60, v64, v64
    v_fmac_f32 v61, v65, v65
    v_sub_f32 v64, v15, v62
    v_sub_f32 v65, v25, v63
    v_fmac_f32 v60, v64, v64
    v_fmac_f32 v61, v65, v65
    v_sub_f32 v64, v16, v62
    v_sub_f32 v65, v26, v63
    v_fmac_f32 v60, v64, v64
    v_fmac_f32 v61, v65, v65
    v_sub_f32 v64, v17, v62
    v_sub_f32 v65, v27, v63
    v_fmac_f32 v60, v64, v64
    v_fmac_f32 v61, v65, v65
    v_sub_f32 v64, v18, v62
    v_sub_f32 v65, v28, v63
    v_fmac_f32 v60, v64, v64
    v_fmac_f32 v61, v65, v65
    s_nop 1
    v_add_f32_dpp v60, v60, v60 row_shr:1 row_mask:0xf bank_mask:0xf bound_ctrl:0
    v_add_f32_dpp v61, v61, v61 row_shr:1 row_mask:0xf bank_mask:0xf bound_ctrl:0
    s_nop 1
    v_add_f32_dpp v60, v60, v60 row_shr:2 row_mask:0xf bank_mask:0xf bound_ctrl:0
    v_add_f32_dpp v61, v61, v61 row_shr:2 row_mask:0xf bank_mask:0xf bound_ctrl:0
    s_nop 1
    v_add_f32_dpp v60, v60, v60 row_shr:4 row_mask:0xf bank_mask:0xf bound_ctrl:0
    v_add_f32_dpp v61, v61, v61 row_shr:4 row_mask:0xf bank_mask:0xf bound_ctrl:0
    s_nop 1
    v_add_f32_dpp v60, v60, v60 row_shr:8 row_mask:0xf bank_mask:0xf bound_ctrl:0
    v_add_f32_dpp v61, v61, v61 row_shr:8 row_mask:0xf bank_mask:0xf bound_ctrl:0
    s_nop 1
    v_add_f32_dpp v60, v60, v60 row_bcast:15 row_mask:0xa bank_mask:0xf
    v_add_f32_dpp v61, v61, v61 row_bcast:15 row_mask:0xa bank_mask:0xf
    s_nop 1
    v_add_f32_dpp v60, v60, v60 row_bcast:31 row_mask:0xc bank_mask:0xf
    v_add_f32_dpp v61, v61, v61 row_bcast:31 row_mask:0xc bank_mask:0xf
    s_nop 1
    v_readlane_b32 s46, v60, 63
    v_readlane_b32 s47, v61, 63
    s_nop 1
    v_mul_f32 v66, s46, v70
    v_mul_f32 v67, s47, v70
    v_cvt_pk_bf16_f32 v68, v66, v67
    v_lshlrev_b32 v66, 16, v68
    v_and_b32 v67, 0xffff0000, v68
    v_cvt_pk_bf16_f32 v69, v62, v63
    v_lshlrev_b32 v62, 16, v69
    v_and_b32 v63, 0xffff0000, v69
    v_add_f32 v66, 0x37280000, v66
    v_add_f32 v67, 0x37280000, v67
    v_cvt_pk_bf16_f32 v68, v66, v67
    v_lshlrev_b32 v66, 16, v68
    v_and_b32 v67, 0xffff0000, v68
    v_sqrt_f32 v66, v66
    v_sqrt_f32 v67, v67
    s_nop 0
    v_cvt_pk_bf16_f32 v68, v66, v67
    v_lshlrev_b32 v66, 16, v68
    v_and_b32 v67, 0xffff0000, v68
    v_rcp_f32 v66, v66
    v_rcp_f32 v67, v67
    v_sub_f32 v30, v10, v62
    v_sub_f32 v31, v20, v63
    v_cvt_pk_bf16_f32 v68, v30, v31
    v_lshlrev_b32 v30, 16, v68
    v_and_b32 v31, 0xffff0000, v68
    v_mul_f32 v30, v30, v66
    v_mul_f32 v31, v31, v67
    v_cvt_pk_bf16_f32 v64, v30, v31
    v_lshlrev_b32 v30, 16, v64
    v_and_b32 v31, 0xffff0000, v64
    v_sub_f32 v32, v11, v62
    v_sub_f32 v33, v21, v63
    v_cvt_pk_bf16_f32 v69, v32, v33
    v_lshlrev_b32 v32, 16, v69
    v_and_b32 v33, 0xffff0000, v69
    v_mul_f32 v32, v32, v66
    v_mul_f32 v33, v33, v67
    v_cvt_pk_bf16_f32 v65, v32, v33
    v_lshlrev_b32 v32, 16, v65
    v_and_b32 v33, 0xffff0000, v65
    v_sub_f32 v34, v12, v62
    v_sub_f32 v35, v22, v63
    v_cvt_pk_bf16_f32 v68, v34, v35
    v_lshlrev_b32 v34, 16, v68
    v_and_b32 v35, 0xffff0000, v68
    v_mul_f32 v34, v34, v66
    v_mul_f32 v35, v35, v67
    v_cvt_pk_bf16_f32 v64, v34, v35
    v_lshlrev_b32 v34, 16, v64
    v_and_b32 v35, 0xffff0000, v64
    v_sub_f32 v36, v13, v62
    v_sub_f32 v37, v23, v63
    v_cvt_pk_bf16_f32 v69, v36, v37
    v_lshlrev_b32 v36, 16, v69
    v_and_b32 v37, 0xffff0000, v69
    v_mul_f32 v36, v36, v66
    v_mul_f32 v37, v37, v67
    v_cvt_pk_bf16_f32 v65, v36, v37
    v_lshlrev_b32 v36, 16, v65
    v_and_b32 v37, 0xffff0000, v65
    v_sub_f32 v38, v14, v62
    v_sub_f32 v39, v24, v63
    v_cvt_pk_bf16_f32 v68, v38, v39
    v_lshlrev_b32 v38, 16, v68
    v_and_b32 v39, 0xffff0000, v68
    v_mul_f32 v38, v38, v66
    v_mul_f32 v39, v39, v67
    v_cvt_pk_bf16_f32 v64, v38, v39
    v_lshlrev_b32 v38, 16, v64
    v_and_b32 v39, 0xffff0000, v64
    v_sub_f32 v40, v15, v62
    v_sub_f32 v41, v25, v63
    v_cvt_pk_bf16_f32 v69, v40, v41
    v_lshlrev_b32 v40, 16, v69
    v_and_b32 v41, 0xffff0000, v69
    v_mul_f32 v40, v40, v66
    v_mul_f32 v41, v41, v67
    v_cvt_pk_bf16_f32 v65, v40, v41
    v_lshlrev_b32 v40, 16, v65
    v_and_b32 v41, 0xffff0000, v65
    v_sub_f32 v42, v16, v62
    v_sub_f32 v43, v26, v63
    v_cvt_pk_bf16_f32 v68, v42, v43
    v_lshlrev_b32 v42, 16, v68
    v_and_b32 v43, 0xffff0000, v68
    v_mul_f32 v42, v42, v66
    v_mul_f32 v43, v43, v67
    v_cvt_pk_bf16_f32 v64, v42, v43
    v_lshlrev_b32 v42, 16, v64
    v_and_b32 v43, 0xffff0000, v64
    v_sub_f32 v44, v17, v62
    v_sub_f32 v45, v27, v63
    v_cvt_pk_bf16_f32 v69, v44, v45
    v_lshlrev_b32 v44, 16, v69
    v_and_b32 v45, 0xffff0000, v69
    v_mul_f32 v44, v44, v66
    v_mul_f32 v45, v45, v67
    v_cvt_pk_bf16_f32 v65, v44, v45
    v_lshlrev_b32 v44, 16, v65
    v_and_b32 v45, 0xffff0000, v65
    v_sub_f32 v46, v18, v62
    v_sub_f32 v47, v28, v63
    v_cvt_pk_bf16_f32 v68, v46, v47
    v_lshlrev_b32 v46, 16, v68
    v_and_b32 v47, 0xffff0000, v68
    v_mul_f32 v46, v46, v66
    v_mul_f32 v47, v47, v67
    v_cvt_pk_bf16_f32 v64, v46, v47
    v_lshlrev_b32 v46, 16, v64
    v_and_b32 v47, 0xffff0000, v64
    v_add_f32 v60, v30, v32
    v_add_f32 v61, v31, v33
    v_add_f32 v60, v60, v34
    v_add_f32 v61, v61, v35
    v_add_f32 v60, v60, v36
    v_add_f32 v61, v61, v37
    v_add_f32 v60, v60, v38
    v_add_f32 v61, v61, v39
    v_add_f32 v60, v60, v40
    v_add_f32 v61, v61, v41
    v_add_f32 v60, v60, v42
    v_add_f32 v61, v61, v43
    v_add_f32 v60, v60, v44
    v_add_f32 v61, v61, v45
    v_add_f32 v60, v60, v46
    v_add_f32 v61, v61, v47
    s_nop 1
    v_add_f32_dpp v60, v60, v60 row_shr:1 row_mask:0xf bank_mask:0xf bound_ctrl:0
    v_add_f32_dpp v61, v61, v61 row_shr:1 row_mask:0xf bank_mask:0xf bound_ctrl:0
    s_nop 1
    v_add_f32_dpp v60, v60, v60 row_shr:2 row_mask:0xf bank_mask:0xf bound_ctrl:0
    v_add_f32_dpp v61, v61, v61 row_shr:2 row_mask:0xf bank_mask:0xf bound_ctrl:0
    s_nop 1
    v_add_f32_dpp v60, v60, v60 row_shr:4 row_mask:0xf bank_mask:0xf bound_ctrl:0
    v_add_f32_dpp v61, v61, v61 row_shr:4 row_mask:0xf bank_mask:0xf bound_ctrl:0
    s_nop 1
    v_add_f32_dpp v60, v60, v60 row_shr:8 row_mask:0xf bank_mask:0xf bound_ctrl:0
    v_add_f32_dpp v61, v61, v61 row_shr:8 row_mask:0xf bank_mask:0xf bound_ctrl:0
    s_nop 1
    v_add_f32_dpp v60, v60, v60 row_bcast:15 row_mask:0xa bank_mask:0xf
    v_add_f32_dpp v61, v61, v61 row_bcast:15 row_mask:0xa bank_mask:0xf
    s_nop 1
    v_add_f32_dpp v60, v60, v60 row_bcast:31 row_mask:0xc bank_mask:0xf
    v_add_f32_dpp v61, v61, v61 row_bcast:31 row_mask:0xc bank_mask:0xf
    s_nop 1
    v_readlane_b32 s44, v60, 63
    v_readlane_b32 s45, v61, 63
    s_nop 1
    v_mov_b32 v70, 0x3ae38e39
    v_mul_f32 v62, s44, v70
    v_mul_f32 v63, s45, v70
    v_sub_f32 v64, v30, v62
    v_sub_f32 v65, v31, v63
    v_mul_f32 v60, v64, v64
    v_mul_f32 v61, v65, v65
    v_sub_f32 v64, v32, v62
    v_sub_f32 v65, v33, v63
    v_fmac_f32 v60, v64, v64
    v_fmac_f32 v61, v65, v65
    v_sub_f32 v64, v34, v62
    v_sub_f32 v65, v35, v63
    v_fmac_f32 v60, v64, v64
    v_fmac_f32 v61, v65, v65
    v_sub_f32 v64, v36, v62
    v_sub_f32 v65, v37, v63
    v_fmac_f32 v60, v64, v64
    v_fmac_f32 v61, v65, v65
    v_sub_f32 v64, v38, v62
    v_sub_f32 v65, v39, v63
    v_fmac_f32 v60, v64, v64
    v_fmac_f32 v61, v65, v65
    v_sub_f32 v64, v40, v62
    v_sub_f32 v65, v41, v63
    v_fmac_f32 v60, v64, v64
    v_fmac_f32 v61, v65, v65
    v_sub_f32 v64, v42, v62
    v_sub_f32 v65, v43, v63
    v_fmac_f32 v60, v64, v64
    v_fmac_f32 v61, v65, v65
    v_sub_f32 v64, v44, v62
    v_sub_f32 v65, v45, v63
    v_fmac_f32 v60, v64, v64
    v_fmac_f32 v61, v65, v65
    v_sub_f32 v64, v46, v62
    v_sub_f32 v65, v47, v63
    v_fmac_f32 v60, v64, v64
    v_fmac_f32 v61, v65, v65
    s_nop 1
    v_add_f32_dpp v60, v60, v60 row_shr:1 row_mask:0xf bank_mask:0xf bound_ctrl:0
    v_add_f32_dpp v61, v61, v61 row_shr:1 row_mask:0xf bank_mask:0xf bound_ctrl:0
    s_nop 1
    v_add_f32_dpp v60, v60, v60 row_shr:2 row_mask:0xf bank_mask:0xf bound_ctrl:0
    v_add_f32_dpp v61, v61, v61 row_shr:2 row_mask:0xf bank_mask:0xf bound_ctrl:0
    s_nop 1
    v_add_f32_dpp v60, v60, v60 row_shr:4 row_mask:0xf bank_mask:0xf bound_ctrl:0
    v_add_f32_dpp v61, v61, v61 row_shr:4 row_mask:0xf bank_mask:0xf bound_ctrl:0
    s_nop 1
    v_add_f32_dpp v60, v60, v60 row_shr:8 row_mask:0xf bank_mask:0xf bound_ctrl:0
    v_add_f32_dpp v61, v61, v61 row_shr:8 row_mask:0xf bank_mask:0xf bound_ctrl:0
    s_nop 1
    v_add_f32_dpp v60, v60, v60 row_bcast:15 row_mask:0xa bank_mask:0xf
    v_add_f32_dpp v61, v61, v61 row_bcast:15 row_mask:0xa bank_mask:0xf
    s_nop 1
    v_add_f32_dpp v60, v60, v60 row_bcast:31 row_mask:0xc bank_mask:0xf
    v_add_f32_dpp v61, v61, v61 row_bcast:31 row_mask:0xc bank_mask:0xf
    s_nop 1
    v_readlane_b32 s46, v60, 63
    v_readlane_b32 s47, v61, 63
    s_nop 1
    v_mul_f32 v66, s46, v70
    v_mul_f32 v67, s47, v70
    v_cvt_pk_bf16_f32 v68, v66, v67
    v_lshlrev_b32 v66, 16, v68
    v_and_b32 v67, 0xffff0000, v68
    v_cvt_pk_bf16_f32 v69, v62, v63
    v_lshlrev_b32 v62, 16, v69
    v_and_b32 v63, 0xffff0000, v69
    v_add_f32 v66, 0x37280000, v66
    v_add_f32 v67, 0x37280000, v67
    v_cvt_pk_bf16_f32 v68, v66, v67
    v_lshlrev_b32 v66, 16, v68
    v_and_b32 v67, 0xffff0000, v68
    v_sqrt_f32 v66, v66
    v_sqrt_f32 v67, v67
    s_nop 0
    v_cvt_pk_bf16_f32 v68, v66, v67
    v_lshlrev_b32 v66, 16, v68
    v_and_b32 v67, 0xffff0000, v68
    v_rcp_f32 v66, v66
    v_rcp_f32 v67, v67
    v_sub_f32 v10, v30, v62
    v_sub_f32 v20, v31, v63
    v_cvt_pk_bf16_f32 v68, v10, v20
    v_lshlrev_b32 v10, 16, v68
    v_and_b32 v20, 0xffff0000, v68
    v_mul_f32 v10, v10, v66
    v_mul_f32 v20, v20, v67
    v_cvt_pk_bf16_f32 v64, v10, v20
    v_lshlrev_b32 v10, 16, v64
    v_and_b32 v20, 0xffff0000, v64
    v_sub_f32 v11, v32, v62
    v_sub_f32 v21, v33, v63
    v_cvt_pk_bf16_f32 v69, v11, v21
    v_lshlrev_b32 v11, 16, v69
    v_and_b32 v21, 0xffff0000, v69
    v_mul_f32 v11, v11, v66
    v_mul_f32 v21, v21, v67
    v_cvt_pk_bf16_f32 v65, v11, v21
    v_lshlrev_b32 v11, 16, v65
    v_and_b32 v21, 0xffff0000, v65
    v_sub_f32 v12, v34, v62
    v_sub_f32 v22, v35, v63
    v_cvt_pk_bf16_f32 v68, v12, v22
    v_lshlrev_b32 v12, 16, v68
    v_and_b32 v22, 0xffff0000, v68
    v_mul_f32 v12, v12, v66
    v_mul_f32 v22, v22, v67
    v_cvt_pk_bf16_f32 v64, v12, v22
    v_lshlrev_b32 v12, 16, v64
    v_and_b32 v22, 0xffff0000, v64
    v_sub_f32 v13, v36, v62
    v_sub_f32 v23, v37, v63
    v_cvt_pk_bf16_f32 v69, v13, v23
    v_lshlrev_b32 v13, 16, v69
    v_and_b32 v23, 0xffff0000, v69
    v_mul_f32 v13, v13, v66
    v_mul_f32 v23, v23, v67
    v_cvt_pk_bf16_f32 v65, v13, v23
    v_lshlrev_b32 v13, 16, v65
    v_and_b32 v23, 0xffff0000, v65
    v_sub_f32 v14, v38, v62
    v_sub_f32 v24, v39, v63
    v_cvt_pk_bf16_f32 v68, v14, v24
    v_lshlrev_b32 v14, 16, v68
    v_and_b32 v24, 0xffff0000, v68
    v_mul_f32 v14, v14, v66
    v_mul_f32 v24, v24, v67
    v_cvt_pk_bf16_f32 v64, v14, v24
    v_lshlrev_b32 v14, 16, v64
    v_and_b32 v24, 0xffff0000, v64
    v_sub_f32 v15, v40, v62
    v_sub_f32 v25, v41, v63
    v_cvt_pk_bf16_f32 v69, v15, v25
    v_lshlrev_b32 v15, 16, v69
    v_and_b32 v25, 0xffff0000, v69
    v_mul_f32 v15, v15, v66
    v_mul_f32 v25, v25, v67
    v_cvt_pk_bf16_f32 v65, v15, v25
    v_lshlrev_b32 v15, 16, v65
    v_and_b32 v25, 0xffff0000, v65
    v_sub_f32 v16, v42, v62
    v_sub_f32 v26, v43, v63
    v_cvt_pk_bf16_f32 v68, v16, v26
    v_lshlrev_b32 v16, 16, v68
    v_and_b32 v26, 0xffff0000, v68
    v_mul_f32 v16, v16, v66
    v_mul_f32 v26, v26, v67
    v_cvt_pk_bf16_f32 v64, v16, v26
    v_lshlrev_b32 v16, 16, v64
    v_and_b32 v26, 0xffff0000, v64
    v_sub_f32 v17, v44, v62
    v_sub_f32 v27, v45, v63
    v_cvt_pk_bf16_f32 v69, v17, v27
    v_lshlrev_b32 v17, 16, v69
    v_and_b32 v27, 0xffff0000, v69
    v_mul_f32 v17, v17, v66
    v_mul_f32 v27, v27, v67
    v_cvt_pk_bf16_f32 v65, v17, v27
    v_lshlrev_b32 v17, 16, v65
    v_and_b32 v27, 0xffff0000, v65
    v_sub_f32 v18, v46, v62
    v_sub_f32 v28, v47, v63
    v_cvt_pk_bf16_f32 v68, v18, v28
    v_lshlrev_b32 v18, 16, v68
    v_and_b32 v28, 0xffff0000, v68
    v_mul_f32 v18, v18, v66
    v_mul_f32 v28, v28, v67
    v_cvt_pk_bf16_f32 v64, v18, v28
    v_lshlrev_b32 v18, 16, v64
    v_and_b32 v28, 0xffff0000, v64
    v_lshlrev_b32 v9, 4, v2
    s_lshl_b32 s22, s33, 2
    v_add_u32 v9, s22, v9
    v_cvt_pk_bf16_f32 v50, v10, v20
    v_cvt_pk_bf16_f32 v51, v11, v21
    v_cvt_pk_bf16_f32 v52, v12, v22
    v_cvt_pk_bf16_f32 v53, v13, v23
    v_cvt_pk_bf16_f32 v54, v14, v24
    v_cvt_pk_bf16_f32 v55, v15, v25
    v_cvt_pk_bf16_f32 v56, v16, v26
    v_cvt_pk_bf16_f32 v57, v17, v27
    v_cvt_pk_bf16_f32 v58, v18, v28
    ds_write_b32 v9, v50 offset:0
    ds_write_b32 v9, v51 offset:1024
    ds_write_b32 v9, v52 offset:2048
    ds_write_b32 v9, v53 offset:3072
    ds_write_b32 v9, v54 offset:4096
    ds_write_b32 v9, v55 offset:5120
    ds_write_b32 v9, v56 offset:6144
    ds_write_b32 v9, v57 offset:7168
    ds_write_b32 v9, v58 offset:8192
    v_add_f32 v98, v36, v42
    v_add_f32 v99, v37, v43
    v_sub_f32 v100, v36, v42
    v_sub_f32 v101, v37, v43
    v_add_f32 v102, v30, v98
    v_add_f32 v103, v31, v99
    v_fmamk_f32 v104, v98, 0xbf000000, v30
    v_fmamk_f32 v105, v99, 0xbf000000, v31
    v_fmamk_f32 v98, v101, 0x3f5db3d7, v104
    v_fmamk_f32 v99, v100, 0xbf5db3d7, v105
    v_fmamk_f32 v106, v101, 0xbf5db3d7, v104
    v_fmamk_f32 v107, v100, 0x3f5db3d7, v105
    v_add_f32 v100, v38, v44
    v_add_f32 v101, v39, v45
    v_sub_f32 v104, v38, v44
    v_sub_f32 v105, v39, v45
    v_add_f32 v108, v32, v100
    v_add_f32 v109, v33, v101
    v_fmamk_f32 v110, v100, 0xbf000000, v32
    v_fmamk_f32 v111, v101, 0xbf000000, v33
    v_fmamk_f32 v100, v105, 0x3f5db3d7, v110
    v_fmamk_f32 v101, v104, 0xbf5db3d7, v111
    v_fmamk_f32 v112, v105, 0xbf5db3d7, v110
    v_fmamk_f32 v113, v104, 0x3f5db3d7, v111
    v_mul_f32 v104, 0x3f441b7d, v100
    v_fmamk_f32 v105, v101, 0x3f248dbb, v104
    v_mul_f32 v104, 0xbf248dbb, v100
    v_fmamk_f32 v110, v101, 0x3f441b7d, v104
    v_mul_f32 v100, 0x3e31d0d4, v112
    v_fmamk_f32 v101, v113, 0x3f7c1c5c, v100
    v_mul_f32 v100, 0xbf7c1c5c, v112
    v_fmamk_f32 v104, v113, 0x3e31d0d4, v100
    v_add_f32 v100, v40, v46
    v_add_f32 v111, v41, v47
    v_sub_f32 v112, v40, v46
    v_sub_f32 v113, v41, v47
    v_add_f32 v114, v34, v100
    v_add_f32 v115, v35, v111
    v_fmamk_f32 v116, v100, 0xbf000000, v34
    v_fmamk_f32 v117, v111, 0xbf000000, v35
    v_fmamk_f32 v100, v113, 0x3f5db3d7, v116
    v_fmamk_f32 v111, v112, 0xbf5db3d7, v117
    v_fmamk_f32 v118, v113, 0xbf5db3d7, v116
    v_fmamk_f32 v119, v112, 0x3f5db3d7, v117
    v_mul_f32 v112, 0x3e31d0d4, v100
    v_fmamk_f32 v113, v111, 0x3f7c1c5c, v112
    v_mul_f32 v112, 0xbf7c1c5c, v100
    v_fmamk_f32 v116, v111, 0x3e31d0d4, v112
    v_mul_f32 v100, 0xbf708fb2, v118
    v_fmamk_f32 v111, v119, 0x3eaf1d44, v100
    v_mul_f32 v100, 0xbeaf1d44, v118
    v_fmamk_f32 v112, v119, 0xbf708fb2, v100
    v_add_f32 v100, v108, v114
    v_add_f32 v117, v109, v115
    v_sub_f32 v118, v108, v114
    v_sub_f32 v119, v109, v115
    v_add_f32 v108, v102, v100
    v_add_f32 v109, v103, v117
    v_fmamk_f32 v114, v100, 0xbf000000, v102
    v_fmamk_f32 v115, v117, 0xbf000000, v103
    v_fmamk_f32 v100, v119, 0x3f5db3d7, v114
    v_fmamk_f32 v102, v118, 0xbf5db3d7, v115
    v_fmamk_f32 v103, v119, 0xbf5db3d7, v114
    v_fmamk_f32 v117, v118, 0x3f5db3d7, v115
    v_add_f32 v114, v105, v113
    v_add_f32 v115, v110, v116
    v_sub_f32 v118, v105, v113
    v_sub_f32 v119, v110, v116
    v_add_f32 v105, v98, v114
    v_add_f32 v110, v99, v115
    v_fmamk_f32 v113, v114, 0xbf000000, v98
    v_fmamk_f32 v116, v115, 0xbf000000, v99
    v_fmamk_f32 v98, v119, 0x3f5db3d7, v113
    v_fmamk_f32 v99, v118, 0xbf5db3d7, v116
    v_fmamk_f32 v114, v119, 0xbf5db3d7, v113
    v_fmamk_f32 v115, v118, 0x3f5db3d7, v116
    v_add_f32 v113, v101, v111
    v_add_f32 v116, v104, v112
    v_sub_f32 v118, v101, v111
    v_sub_f32 v119, v104, v112
    v_add_f32 v101, v106, v113
    v_add_f32 v104, v107, v116
    v_fmamk_f32 v111, v113, 0xbf000000, v106
    v_fmamk_f32 v112, v116, 0xbf000000, v107
    v_fmamk_f32 v106, v119, 0x3f5db3d7, v111
    v_fmamk_f32 v107, v118, 0xbf5db3d7, v112
    v_fmamk_f32 v113, v119, 0xbf5db3d7, v111
    v_fmamk_f32 v116, v118, 0x3f5db3d7, v112
    s_mul_i32 s22, s33, 5184
    v_lshlrev_b32 v9, 3, v2
    v_add_u32 v9, s22, v9
    v_mov_b32 v60, v108
    v_mov_b32 v61, v109
    v_mul_f32 v108, v105, v82
    v_fma_f32 v62, -v110, v83, v108
    v_mul_f32 v108, v105, v83
    v_fma_f32 v63, v110, v82, v108
    v_mul_f32 v105, v101, v84
    v_fma_f32 v64, -v104, v85, v105
    v_mul_f32 v105, v101, v85
    v_fma_f32 v65, v104, v84, v105
    v_mul_f32 v101, v100, v86
    v_fma_f32 v66, -v102, v87, v101
    v_mul_f32 v101, v100, v87
    v_fma_f32 v67, v102, v86, v101
    v_mul_f32 v100, v98, v88
    v_fma_f32 v68, -v99, v89, v100
    v_mul_f32 v100, v98, v89
    v_fma_f32 v69, v99, v88, v100
    v_mul_f32 v98, v106, v90
    v_fma_f32 v70, -v107, v91, v98
    v_mul_f32 v98, v106, v91
    v_fma_f32 v71, v107, v90, v98
    v_mul_f32 v98, v103, v92
    v_fma_f32 v72, -v117, v93, v98
    v_mul_f32 v98, v103, v93
    v_fma_f32 v73, v117, v92, v98
    v_mul_f32 v98, v114, v94
    v_fma_f32 v74, -v115, v95, v98
    v_mul_f32 v98, v114, v95
    v_fma_f32 v75, v115, v94, v98
    v_mul_f32 v98, v113, v96
    v_fma_f32 v76, -v116, v97, v98
    v_mul_f32 v98, v113, v97
    v_fma_f32 v77, v116, v96, v98
    ds_write_b64 v9, v[60:61] offset:9216
    ds_write_b64 v9, v[62:63] offset:9792
    ds_write_b64 v9, v[64:65] offset:10368
    ds_write_b64 v9, v[66:67] offset:10944
    ds_write_b64 v9, v[68:69] offset:11520
    ds_write_b64 v9, v[70:71] offset:12096
    ds_write_b64 v9, v[72:73] offset:12672
    ds_write_b64 v9, v[74:75] offset:13248
    ds_write_b64 v9, v[76:77] offset:13824
L_a_skipln:
    v_cvt_f32_u32 v60, v6
    v_mul_f32 v61, 0xbc800000, v60
    v_cos_f32 v82, v61
    v_sin_f32 v83, v61
    v_mul_f32 v61, 0xbd000000, v60
    v_cos_f32 v84, v61
    v_sin_f32 v85, v61
    v_mul_f32 v61, 0xbd400000, v60
    v_cos_f32 v86, v61
    v_sin_f32 v87, v61
    v_mul_f32 v61, 0xbd800000, v60
    v_cos_f32 v88, v61
    v_sin_f32 v89, v61
    v_mul_f32 v61, 0xbda00000, v60
    v_cos_f32 v90, v61
    v_sin_f32 v91, v61
    v_mul_f32 v61, 0xbdc00000, v60
    v_cos_f32 v92, v61
    v_sin_f32 v93, v61
    v_mul_f32 v61, 0xbde00000, v60
    v_cos_f32 v94, v61
    v_sin_f32 v95, v61
    s_waitcnt lgkmcnt(0)
    s_barrier
    v_cmp_gt_u32 vcc, 288, v0
    s_and_saveexec_b64 s[30:31], vcc
    v_lshlrev_b32 v9, 4, v0
    ds_read_b128 v[10:13], v9
    ds_read_b128 v[14:17], v9 offset:4608
    v_lshlrev_b32 v20, 3, v6
    v_add_u32 v20, v7, v20
    ds_read_b64 v[30:31], v20 offset:9216
    ds_read_b64 v[32:33], v20 offset:9280
    ds_read_b64 v[34:35], v20 offset:9344
    ds_read_b64 v[36:37], v20 offset:9408
    ds_read_b64 v[38:39], v20 offset:9472
    ds_read_b64 v[40:41], v20 offset:9536
    ds_read_b64 v[42:43], v20 offset:9600
    ds_read_b64 v[44:45], v20 offset:9664
    s_mul_i32 s23, s2, 9216
    s_waitcnt lgkmcnt(8)
    buffer_store_dwordx4 v[10:13], v9, s[16:19], s23 offen sc0 sc1
    v_add_u32 v21, 4608, v9
    buffer_store_dwordx4 v[14:17], v21, s[16:19], s23 offen sc0 sc1
    s_waitcnt lgkmcnt(0)
    v_add_f32 v98, v30, v38
    v_add_f32 v99, v31, v39
    v_sub_f32 v100, v30, v38
    v_sub_f32 v101, v31, v39
    v_add_f32 v102, v32, v40
    v_add_f32 v103, v33, v41
    v_sub_f32 v104, v32, v40
    v_sub_f32 v105, v33, v41
    v_mul_f32 v106, 0x3f3504f3, v104
    v_fmamk_f32 v107, v105, 0x3f3504f3, v106
    v_mul_f32 v106, 0xbf3504f3, v104
    v_fmamk_f32 v108, v105, 0x3f3504f3, v106
    v_add_f32 v104, v34, v42
    v_add_f32 v105, v35, v43
    v_sub_f32 v106, v34, v42
    v_sub_f32 v109, v35, v43
    v_add_f32 v110, v36, v44
    v_add_f32 v111, v37, v45
    v_sub_f32 v112, v36, v44
    v_sub_f32 v113, v37, v45
    v_mul_f32 v114, 0xbf3504f3, v112
    v_fmamk_f32 v115, v113, 0x3f3504f3, v114
    v_mul_f32 v114, 0xbf3504f3, v112
    v_fmamk_f32 v116, v113, 0xbf3504f3, v114
    v_add_f32 v112, v98, v104
    v_add_f32 v113, v99, v105
    v_sub_f32 v114, v98, v104
    v_sub_f32 v117, v99, v105
    v_add_f32 v118, v102, v110
    v_add_f32 v119, v103, v111
    v_sub_f32 v120, v102, v110
    v_sub_f32 v121, v103, v111
    v_add_f32 v98, v112, v118
    v_add_f32 v99, v113, v119
    v_sub_f32 v102, v112, v118
    v_sub_f32 v103, v113, v119
    v_add_f32 v104, v114, v121
    v_sub_f32 v105, v117, v120
    v_sub_f32 v110, v114, v121
    v_add_f32 v111, v117, v120
    v_add_f32 v112, v100, v109
    v_sub_f32 v113, v101, v106
    v_sub_f32 v114, v100, v109
    v_add_f32 v117, v101, v106
    v_add_f32 v118, v107, v115
    v_add_f32 v119, v108, v116
    v_sub_f32 v120, v107, v115
    v_sub_f32 v121, v108, v116
    v_add_f32 v100, v112, v118
    v_add_f32 v101, v113, v119
    v_sub_f32 v106, v112, v118
    v_sub_f32 v107, v113, v119
    v_add_f32 v108, v114, v121
    v_sub_f32 v109, v117, v120
    v_sub_f32 v115, v114, v121
    v_add_f32 v116, v117, v120
    v_mul_u32_u24 v22, 72, v6
    v_add_u32 v22, v7, v22
    v_mov_b32 v60, v98
    v_mov_b32 v61, v99
    v_mul_f32 v98, v100, v82
    v_fma_f32 v62, -v101, v83, v98
    v_mul_f32 v98, v100, v83
    v_fma_f32 v63, v101, v82, v98
    v_mul_f32 v98, v104, v84
    v_fma_f32 v64, -v105, v85, v98
    v_mul_f32 v98, v104, v85
    v_fma_f32 v65, v105, v84, v98
    v_mul_f32 v98, v108, v86
    v_fma_f32 v66, -v109, v87, v98
    v_mul_f32 v98, v108, v87
    v_fma_f32 v67, v109, v86, v98
    v_mul_f32 v98, v102, v88
    v_fma_f32 v68, -v103, v89, v98
    v_mul_f32 v98, v102, v89
    v_fma_f32 v69, v103, v88, v98
    v_mul_f32 v98, v106, v90
    v_fma_f32 v70, -v107, v91, v98
    v_mul_f32 v98, v106, v91
    v_fma_f32 v71, v107, v90, v98
    v_mul_f32 v98, v110, v92
    v_fma_f32 v72, -v111, v93, v98
    v_mul_f32 v98, v110, v93
    v_fma_f32 v73, v111, v92, v98
    v_mul_f32 v98, v115, v94
    v_fma_f32 v74, -v116, v95, v98
    v_mul_f32 v98, v115, v95
    v_fma_f32 v75, v116, v94, v98
    ds_write_b64 v22, v[60:61] offset:29952
    ds_write_b64 v22, v[62:63] offset:29960
    ds_write_b64 v22, v[64:65] offset:29968
    ds_write_b64 v22, v[66:67] offset:29976
    ds_write_b64 v22, v[68:69] offset:29984
    ds_write_b64 v22, v[70:71] offset:29992
    ds_write_b64 v22, v[72:73] offset:30000
    ds_write_b64 v22, v[74:75] offset:30008
    s_waitcnt lgkmcnt(0)
    s_barrier
    ds_read_b64 v[30:31], v20 offset:29952
    ds_read_b64 v[32:33], v20 offset:30024
    ds_read_b64 v[34:35], v20 offset:30096
    ds_read_b64 v[36:37], v20 offset:30168
    ds_read_b64 v[38:39], v20 offset:30240
    ds_read_b64 v[40:41], v20 offset:30312
    ds_read_b64 v[42:43], v20 offset:30384
    ds_read_b64 v[44:45], v20 offset:30456
    s_waitcnt lgkmcnt(0)
    v_add_f32 v98, v30, v38
    v_add_f32 v99, v31, v39
    v_sub_f32 v100, v30, v38
    v_sub_f32 v101, v31, v39
    v_add_f32 v102, v32, v40
    v_add_f32 v103, v33, v41
    v_sub_f32 v104, v32, v40
    v_sub_f32 v105, v33, v41
    v_mul_f32 v106, 0x3f3504f3, v104
    v_fmamk_f32 v107, v105, 0x3f3504f3, v106
    v_mul_f32 v106, 0xbf3504f3, v104
    v_fmamk_f32 v108, v105, 0x3f3504f3, v106
    v_add_f32 v104, v34, v42
    v_add_f32 v105, v35, v43
    v_sub_f32 v106, v34, v42
    v_sub_f32 v109, v35, v43
    v_add_f32 v110, v36, v44
    v_add_f32 v111, v37, v45
    v_sub_f32 v112, v36, v44
    v_sub_f32 v113, v37, v45
    v_mul_f32 v114, 0xbf3504f3, v112
    v_fmamk_f32 v115, v113, 0x3f3504f3, v114
    v_mul_f32 v114, 0xbf3504f3, v112
    v_fmamk_f32 v116, v113, 0xbf3504f3, v114
    v_add_f32 v112, v98, v104
    v_add_f32 v113, v99, v105
    v_sub_f32 v114, v98, v104
    v_sub_f32 v117, v99, v105
    v_add_f32 v118, v102, v110
    v_add_f32 v119, v103, v111
    v_sub_f32 v120, v102, v110
    v_sub_f32 v121, v103, v111
    v_add_f32 v60, v112, v118
    v_add_f32 v61, v113, v119
    v_sub_f32 v68, v112, v118
    v_sub_f32 v69, v113, v119
    v_add_f32 v64, v114, v121
    v_sub_f32 v65, v117, v120
    v_sub_f32 v72, v114, v121
    v_add_f32 v73, v117, v120
    v_add_f32 v98, v100, v109
    v_sub_f32 v99, v101, v106
    v_sub_f32 v102, v100, v109
    v_add_f32 v103, v101, v106
    v_add_f32 v104, v107, v115
    v_add_f32 v105, v108, v116
    v_sub_f32 v110, v107, v115
    v_sub_f32 v111, v108, v116
    v_add_f32 v62, v98, v104
    v_add_f32 v63, v99, v105
    v_sub_f32 v70, v98, v104
    v_sub_f32 v71, v99, v105
    v_add_f32 v66, v102, v111
    v_sub_f32 v67, v103, v110
    v_sub_f32 v74, v102, v111
    v_add_f32 v75, v103, v110
    v_mul_u32_u24 v22, 4672, v3
    v_mul_u32_u24 v23, 9, v6
    v_add_u32 v23, v23, v5
    v_lshlrev_b32 v23, 3, v23
    v_add_u32 v22, v22, v23
    ds_write_b64 v22, v[60:61] offset:9216
    ds_write_b64 v22, v[62:63] offset:9792
    ds_write_b64 v22, v[64:65] offset:10368
    ds_write_b64 v22, v[66:67] offset:10944
    ds_write_b64 v22, v[68:69] offset:11520
    ds_write_b64 v22, v[70:71] offset:12096
    ds_write_b64 v22, v[72:73] offset:12672
    ds_write_b64 v22, v[74:75] offset:13248
    s_mov_b64 exec, s[30:31]
    s_waitcnt lgkmcnt(0)
    s_barrier
    s_mul_i32 s23, s2, 18560
    v_add_u32 v10, 0, v0
    v_lshrrev_b32 v11, 2, v10
    v_and_b32 v12, 3, v10
    v_mul_u32_u24 v13, 4672, v12
    v_sub_u32 v14, 576, v11
    v_cmp_eq_u32 vcc, 0, v11
    v_lshlrev_b32 v15, 3, v11
    v_add_u32 v15, v15, v13
    v_cndmask_b32 v14, v14, v11, vcc
    v_lshlrev_b32 v14, 3, v14
    v_add_u32 v14, v14, v13
    ds_read_b64 v[30:31], v15 offset:9216
    ds_read_b64 v[32:33], v14 offset:9216
    v_lshlrev_b32 v70, 4, v10
    s_waitcnt lgkmcnt(0)
    v_add_f32 v34, v30, v32
    v_sub_f32 v35, v31, v33
    v_add_f32 v36, v31, v33
    v_sub_f32 v37, v32, v30
    buffer_store_dwordx4 v[34:37], v70, s[24:27], s23 offen sc0 sc1
    v_add_u32 v10, 320, v0
    v_lshrrev_b32 v11, 2, v10
    v_and_b32 v12, 3, v10
    v_mul_u32_u24 v13, 4672, v12
    v_sub_u32 v14, 576, v11
    v_cmp_eq_u32 vcc, 0, v11
    v_lshlrev_b32 v15, 3, v11
    v_add_u32 v15, v15, v13
    v_cndmask_b32 v14, v14, v11, vcc
    v_lshlrev_b32 v14, 3, v14
    v_add_u32 v14, v14, v13
    ds_read_b64 v[38:39], v15 offset:9216
    ds_read_b64 v[40:41], v14 offset:9216
    v_lshlrev_b32 v71, 4, v10
    s_waitcnt lgkmcnt(0)
    v_add_f32 v42, v38, v40
    v_sub_f32 v43, v39, v41
    v_add_f32 v44, v39, v41
    v_sub_f32 v45, v40, v38
    buffer_store_dwordx4 v[42:45], v71, s[24:27], s23 offen sc0 sc1
    v_add_u32 v10, 640, v0
    v_lshrrev_b32 v11, 2, v10
    v_and_b32 v12, 3, v10
    v_mul_u32_u24 v13, 4672, v12
    v_sub_u32 v14, 576, v11
    v_cmp_eq_u32 vcc, 0, v11
    v_lshlrev_b32 v15, 3, v11
    v_add_u32 v15, v15, v13
    v_cndmask_b32 v14, v14, v11, vcc
    v_lshlrev_b32 v14, 3, v14
    v_add_u32 v14, v14, v13
    ds_read_b64 v[46:47], v15 offset:9216
    ds_read_b64 v[48:49], v14 offset:9216
    v_lshlrev_b32 v72, 4, v10
    s_waitcnt lgkmcnt(0)
    v_add_f32 v50, v46, v48
    v_sub_f32 v51, v47, v49
    v_add_f32 v52, v47, v49
    v_sub_f32 v53, v48, v46
    buffer_store_dwordx4 v[50:53], v72, s[24:27], s23 offen sc0 sc1
    v_add_u32 v10, 960, v0
    v_cmp_gt_u32 vcc, 1156, v10
    s_and_saveexec_b64 s[30:31], vcc
    s_cbranch_execz L_a_unp_done
    v_lshrrev_b32 v11, 2, v10
    v_and_b32 v12, 3, v10
    v_mul_u32_u24 v13, 4672, v12
    v_sub_u32 v14, 576, v11
    v_cmp_eq_u32 vcc, 0, v11
    v_lshlrev_b32 v15, 3, v11
    v_add_u32 v15, v15, v13
    v_cndmask_b32 v14, v14, v11, vcc
    v_lshlrev_b32 v14, 3, v14
    v_add_u32 v14, v14, v13
    ds_read_b64 v[54:55], v15 offset:9216
    ds_read_b64 v[56:57], v14 offset:9216
    v_lshlrev_b32 v73, 4, v10
    s_waitcnt lgkmcnt(0)
    v_add_f32 v58, v54, v56
    v_sub_f32 v59, v55, v57
    v_add_f32 v60, v55, v57
    v_sub_f32 v61, v56, v54
    buffer_store_dwordx4 v[58:61], v73, s[24:27], s23 offen sc0 sc1
L_a_unp_done:
    s_mov_b64 exec, s[30:31]
    s_branch L_phA_done
L_a_aux:
    v_subrev_u32 v1, 320, v0
    s_waitcnt lgkmcnt(0)
    s_cmp_lg_u32 s33, 7
    s_cbranch_scc1 L_a_aux2
    s_mov_b32 s44, s42
    s_mov_b32 s45, s43
    s_mov_b32 s46, 256
    s_mov_b32 s47, 0x00020000
    s_lshl_b32 s21, s2, 7
    v_mov_b32 v9, 0
    v_lshlrev_b32 v10, 15, v2
    buffer_store_dword v9, v10, s[56:59], s21 offen sc0 sc1
    s_waitcnt vmcnt(0)
    v_mov_b32 v9, 1
    v_mov_b32 v10, 0
    s_mov_b64 s[30:31], exec
    s_mov_b64 exec, 1
    buffer_atomic_add v9, v10, s[44:47], 0 offen sc1
    s_mov_b64 exec, s[30:31]
L_a_aux2:
    s_cmp_lt_u32 s2, 64
    s_cbranch_scc1 L_a_wt
    s_mov_b32 s12, s40
    s_mov_b32 s13, s41
    s_mov_b32 s14, 18874368
    s_mov_b32 s15, 0x00020000
    s_and_b32 s22, s2, 7
    s_mul_i32 s22, s22, 1152
    s_lshr_b32 s23, s2, 3
    s_sub_u32 s23, s23, 8
    s_mul_i32 s23, s23, 192
    s_mov_b32 s24, 9216
    v_add_u32 v10, 0, v1
    v_add_u32 v10, s23, v10
    s_mov_b32 s25, 0x1c71c71d
    v_mul_hi_u32 v11, v10, s25
    v_mul_u32_u24 v12, 9, v11
    v_sub_u32 v12, v10, v12
    v_mul_lo_u32 v11, v11, s24
    v_lshlrev_b32 v12, 7, v12
    v_add_u32 v11, v11, v12
    buffer_load_dword v76, v11, s[12:15], s22 offen
    v_add_u32 v10, 4608, v1
    v_add_u32 v10, s23, v10
    s_mov_b32 s25, 0x1c71c71d
    v_mul_hi_u32 v11, v10, s25
    v_mul_u32_u24 v12, 9, v11
    v_sub_u32 v12, v10, v12
    v_mul_lo_u32 v11, v11, s24
    v_lshlrev_b32 v12, 7, v12
    v_add_u32 v11, v11, v12
    buffer_load_dword v76, v11, s[12:15], s22 offen
    v_add_u32 v10, 9216, v1
    v_add_u32 v10, s23, v10
    s_mov_b32 s25, 0x1c71c71d
    v_mul_hi_u32 v11, v10, s25
    v_mul_u32_u24 v12, 9, v11
    v_sub_u32 v12, v10, v12
    v_mul_lo_u32 v11, v11, s24
    v_lshlrev_b32 v12, 7, v12
    v_add_u32 v11, v11, v12
    buffer_load_dword v76, v11, s[12:15], s22 offen
    s_barrier
    s_barrier
    s_barrier
    s_branch L_phA_done2
L_a_wt:
    s_mov_b32 s12, s36
    s_mov_b32 s13, s37
    s_mov_b32 s14, 1183744
    s_mov_b32 s15, 0x00020000
    s_mov_b32 s16, s38
    s_mov_b32 s17, s39
    s_mov_b32 s18, 1183744
    s_mov_b32 s19, 0x00020000
    s_add_u32 s24, s8, 58720256
    s_addc_u32 s25, s9, 0
    s_mov_b32 s26, 2367488
    s_mov_b32 s27, 0x00020000
    s_mul_i32 s22, s2, 18496
    v_lshlrev_b32 v9, 4, v1
    v_add_u32 v10, 0, v9
    buffer_load_dwordx4 v[20:23], v10, s[12:15], s22 offen
    buffer_load_dwordx4 v[24:27], v10, s[16:19], s22 offen
    v_add_u32 v10, 3072, v9
    buffer_load_dwordx4 v[28:31], v10, s[12:15], s22 offen
    buffer_load_dwordx4 v[32:35], v10, s[16:19], s22 offen
    v_add_u32 v10, 6144, v9
    buffer_load_dwordx4 v[36:39], v10, s[12:15], s22 offen
    buffer_load_dwordx4 v[40:43], v10, s[16:19], s22 offen
    v_add_u32 v10, 9216, v9
    buffer_load_dwordx4 v[44:47], v10, s[12:15], s22 offen
    buffer_load_dwordx4 v[48:51], v10, s[16:19], s22 offen
    v_add_u32 v10, 12288, v9
    buffer_load_dwordx4 v[52:55], v10, s[12:15], s22 offen
    buffer_load_dwordx4 v[56:59], v10, s[16:19], s22 offen
    v_add_u32 v10, 15360, v9
    buffer_load_dwordx4 v[60:63], v10, s[12:15], s22 offen
    buffer_load_dwordx4 v[64:67], v10, s[16:19], s22 offen
    v_add_u32 v10, 18432, v9
    v_cmp_gt_u32 vcc, 18496, v10
    s_and_saveexec_b64 s[30:31], vcc
    buffer_load_dwordx4 v[68:71], v10, s[12:15], s22 offen
    buffer_load_dwordx4 v[72:75], v10, s[16:19], s22 offen
    s_mov_b64 exec, s[30:31]
    s_waitcnt vmcnt(0)
    v_add_u32 v10, 0, v9
    ds_write_b128 v10, v[20:23] offset:51200
    v_add_u32 v11, 69696, v10
    ds_write_b128 v11, v[24:27]
    v_add_u32 v10, 3072, v9
    ds_write_b128 v10, v[28:31] offset:51200
    v_add_u32 v11, 69696, v10
    ds_write_b128 v11, v[32:35]
    v_add_u32 v10, 6144, v9
    ds_write_b128 v10, v[36:39] offset:51200
    v_add_u32 v11, 69696, v10
    ds_write_b128 v11, v[40:43]
    v_add_u32 v10, 9216, v9
    ds_write_b128 v10, v[44:47] offset:51200
    v_add_u32 v11, 69696, v10
    ds_write_b128 v11, v[48:51]
    v_add_u32 v10, 12288, v9
    ds_write_b128 v10, v[52:55] offset:51200
    v_add_u32 v11, 69696, v10
    ds_write_b128 v11, v[56:59]
    v_add_u32 v10, 15360, v9
    ds_write_b128 v10, v[60:63] offset:51200
    v_add_u32 v11, 69696, v10
    ds_write_b128 v11, v[64:67]
    v_add_u32 v10, 18432, v9
    v_cmp_gt_u32 vcc, 18496, v10
    s_and_saveexec_b64 s[30:31], vcc
    ds_write_b128 v10, v[68:71] offset:51200
    v_add_u32 v11, 69696, v10
    ds_write_b128 v11, v[72:75]
    s_mov_b64 exec, s[30:31]
    s_waitcnt lgkmcnt(0)
    s_barrier
    s_lshl_b32 s23, s2, 7
    v_and_b32 v11, 7, v1
    v_mul_u32_u24 v12, 2312, v11
    v_lshrrev_b32 v13, 3, v1
    v_lshlrev_b32 v14, 1, v13
    v_add_u32 v12, v12, v14
    v_add_u32 v12, 51200, v12
    v_add_u32 v16, 18496, v12
    v_lshlrev_b32 v14, 13, v13
    v_lshlrev_b32 v15, 4, v11
    v_add_u32 v14, v14, v15
    ds_read_u16 v20, v12 offset:0
    ds_read_u16 v21, v16 offset:0
    ds_read_u16 v22, v12 offset:578
    ds_read_u16 v23, v16 offset:578
    ds_read_u16 v24, v12 offset:1156
    ds_read_u16 v25, v16 offset:1156
    ds_read_u16 v26, v12 offset:1734
    ds_read_u16 v27, v16 offset:1734
    ds_read_u16 v32, v12 offset:48
    ds_read_u16 v33, v16 offset:48
    ds_read_u16 v34, v12 offset:626
    ds_read_u16 v35, v16 offset:626
    ds_read_u16 v36, v12 offset:1204
    ds_read_u16 v37, v16 offset:1204
    ds_read_u16 v38, v12 offset:1782
    ds_read_u16 v39, v16 offset:1782
    ds_read_u16 v44, v12 offset:96
    ds_read_u16 v45, v16 offset:96
    ds_read_u16 v46, v12 offset:674
    ds_read_u16 v47, v16 offset:674
    ds_read_u16 v48, v12 offset:1252
    ds_read_u16 v49, v16 offset:1252
    ds_read_u16 v50, v12 offset:1830
    ds_read_u16 v51, v16 offset:1830
    ds_read_u16 v56, v12 offset:144
    ds_read_u16 v57, v16 offset:144
    ds_read_u16 v58, v12 offset:722
    ds_read_u16 v59, v16 offset:722
    ds_read_u16 v60, v12 offset:1300
    ds_read_u16 v61, v16 offset:1300
    ds_read_u16 v62, v12 offset:1878
    ds_read_u16 v63, v16 offset:1878
    s_waitcnt lgkmcnt(0)
    v_lshl_or_b32 v28, v21, 16, v20
    v_lshl_or_b32 v29, v23, 16, v22
    v_lshl_or_b32 v30, v25, 16, v24
    v_lshl_or_b32 v31, v27, 16, v26
    s_add_u32 s36, s23, 0
    buffer_store_dwordx4 v[28:31], v14, s[24:27], s36 offen sc0 sc1
    v_lshl_or_b32 v40, v33, 16, v32
    v_lshl_or_b32 v41, v35, 16, v34
    v_lshl_or_b32 v42, v37, 16, v36
    v_lshl_or_b32 v43, v39, 16, v38
    s_add_u32 s36, s23, 196608
    buffer_store_dwordx4 v[40:43], v14, s[24:27], s36 offen sc0 sc1
    v_lshl_or_b32 v52, v45, 16, v44
    v_lshl_or_b32 v53, v47, 16, v46
    v_lshl_or_b32 v54, v49, 16, v48
    v_lshl_or_b32 v55, v51, 16, v50
    s_add_u32 s36, s23, 393216
    buffer_store_dwordx4 v[52:55], v14, s[24:27], s36 offen sc0 sc1
    v_lshl_or_b32 v64, v57, 16, v56
    v_lshl_or_b32 v65, v59, 16, v58
    v_lshl_or_b32 v66, v61, 16, v60
    v_lshl_or_b32 v67, v63, 16, v62
    s_add_u32 s36, s23, 589824
    buffer_store_dwordx4 v[64:67], v14, s[24:27], s36 offen sc0 sc1
    s_barrier
    ds_read_u16 v20, v12 offset:192
    ds_read_u16 v21, v16 offset:192
    ds_read_u16 v22, v12 offset:770
    ds_read_u16 v23, v16 offset:770
    ds_read_u16 v24, v12 offset:1348
    ds_read_u16 v25, v16 offset:1348
    ds_read_u16 v26, v12 offset:1926
    ds_read_u16 v27, v16 offset:1926
    ds_read_u16 v32, v12 offset:240
    ds_read_u16 v33, v16 offset:240
    ds_read_u16 v34, v12 offset:818
    ds_read_u16 v35, v16 offset:818
    ds_read_u16 v36, v12 offset:1396
    ds_read_u16 v37, v16 offset:1396
    ds_read_u16 v38, v12 offset:1974
    ds_read_u16 v39, v16 offset:1974
    ds_read_u16 v44, v12 offset:288
    ds_read_u16 v45, v16 offset:288
    ds_read_u16 v46, v12 offset:866
    ds_read_u16 v47, v16 offset:866
    ds_read_u16 v48, v12 offset:1444
    ds_read_u16 v49, v16 offset:1444
    ds_read_u16 v50, v12 offset:2022
    ds_read_u16 v51, v16 offset:2022
    ds_read_u16 v56, v12 offset:336
    ds_read_u16 v57, v16 offset:336
    ds_read_u16 v58, v12 offset:914
    ds_read_u16 v59, v16 offset:914
    ds_read_u16 v60, v12 offset:1492
    ds_read_u16 v61, v16 offset:1492
    ds_read_u16 v62, v12 offset:2070
    ds_read_u16 v63, v16 offset:2070
    s_waitcnt lgkmcnt(0)
    v_lshl_or_b32 v28, v21, 16, v20
    v_lshl_or_b32 v29, v23, 16, v22
    v_lshl_or_b32 v30, v25, 16, v24
    v_lshl_or_b32 v31, v27, 16, v26
    s_add_u32 s36, s23, 786432
    buffer_store_dwordx4 v[28:31], v14, s[24:27], s36 offen sc0 sc1
    v_lshl_or_b32 v40, v33, 16, v32
    v_lshl_or_b32 v41, v35, 16, v34
    v_lshl_or_b32 v42, v37, 16, v36
    v_lshl_or_b32 v43, v39, 16, v38
    s_add_u32 s36, s23, 983040
    buffer_store_dwordx4 v[40:43], v14, s[24:27], s36 offen sc0 sc1
    v_lshl_or_b32 v52, v45, 16, v44
    v_lshl_or_b32 v53, v47, 16, v46
    v_lshl_or_b32 v54, v49, 16, v48
    v_lshl_or_b32 v55, v51, 16, v50
    s_add_u32 s36, s23, 1179648
    buffer_store_dwordx4 v[52:55], v14, s[24:27], s36 offen sc0 sc1
    v_lshl_or_b32 v64, v57, 16, v56
    v_lshl_or_b32 v65, v59, 16, v58
    v_lshl_or_b32 v66, v61, 16, v60
    v_lshl_or_b32 v67, v63, 16, v62
    s_add_u32 s36, s23, 1376256
    buffer_store_dwordx4 v[64:67], v14, s[24:27], s36 offen sc0 sc1
    s_barrier
    ds_read_u16 v20, v12 offset:384
    ds_read_u16 v21, v16 offset:384
    ds_read_u16 v22, v12 offset:962
    ds_read_u16 v23, v16 offset:962
    ds_read_u16 v24, v12 offset:1540
    ds_read_u16 v25, v16 offset:1540
    ds_read_u16 v26, v12 offset:2118
    ds_read_u16 v27, v16 offset:2118
    ds_read_u16 v32, v12 offset:432
    ds_read_u16 v33, v16 offset:432
    ds_read_u16 v34, v12 offset:1010
    ds_read_u16 v35, v16 offset:1010
    ds_read_u16 v36, v12 offset:1588
    ds_read_u16 v37, v16 offset:1588
    ds_read_u16 v38, v12 offset:2166
    ds_read_u16 v39, v16 offset:2166
    ds_read_u16 v44, v12 offset:480
    ds_read_u16 v45, v16 offset:480
    ds_read_u16 v46, v12 offset:1058
    ds_read_u16 v47, v16 offset:1058
    ds_read_u16 v48, v12 offset:1636
    ds_read_u16 v49, v16 offset:1636
    ds_read_u16 v50, v12 offset:2214
    ds_read_u16 v51, v16 offset:2214
    ds_read_u16 v56, v12 offset:528
    ds_read_u16 v57, v16 offset:528
    ds_read_u16 v58, v12 offset:1106
    ds_read_u16 v59, v16 offset:1106
    ds_read_u16 v60, v12 offset:1684
    ds_read_u16 v61, v16 offset:1684
    ds_read_u16 v62, v12 offset:2262
    ds_read_u16 v63, v16 offset:2262
    s_waitcnt lgkmcnt(0)
    v_lshl_or_b32 v28, v21, 16, v20
    v_lshl_or_b32 v29, v23, 16, v22
    v_lshl_or_b32 v30, v25, 16, v24
    v_lshl_or_b32 v31, v27, 16, v26
    s_add_u32 s36, s23, 1572864
    buffer_store_dwordx4 v[28:31], v14, s[24:27], s36 offen sc0 sc1
    v_lshl_or_b32 v40, v33, 16, v32
    v_lshl_or_b32 v41, v35, 16, v34
    v_lshl_or_b32 v42, v37, 16, v36
    v_lshl_or_b32 v43, v39, 16, v38
    s_add_u32 s36, s23, 1769472
    buffer_store_dwordx4 v[40:43], v14, s[24:27], s36 offen sc0 sc1
    v_lshl_or_b32 v52, v45, 16, v44
    v_lshl_or_b32 v53, v47, 16, v46
    v_lshl_or_b32 v54, v49, 16, v48
    v_lshl_or_b32 v55, v51, 16, v50
    s_add_u32 s36, s23, 1966080
    buffer_store_dwordx4 v[52:55], v14, s[24:27], s36 offen sc0 sc1
    v_lshl_or_b32 v64, v57, 16, v56
    v_lshl_or_b32 v65, v59, 16, v58
    v_lshl_or_b32 v66, v61, 16, v60
    v_lshl_or_b32 v67, v63, 16, v62
    s_add_u32 s36, s23, 2162688
    buffer_store_dwordx4 v[64:67], v14, s[24:27], s36 offen sc0 sc1
    v_cmp_gt_u32 vcc, 8, v1
    s_and_saveexec_b64 s[30:31], vcc
    s_cbranch_execz L_a_wt_done
    ds_read_u16 v20, v12 offset:576
    ds_read_u16 v21, v16 offset:576
    ds_read_u16 v22, v12 offset:1154
    ds_read_u16 v23, v16 offset:1154
    ds_read_u16 v24, v12 offset:1732
    ds_read_u16 v25, v16 offset:1732
    ds_read_u16 v26, v12 offset:2310
    ds_read_u16 v27, v16 offset:2310
    s_waitcnt lgkmcnt(0)
    v_lshl_or_b32 v28, v21, 16, v20
    v_lshl_or_b32 v29, v23, 16, v22
    v_lshl_or_b32 v30, v25, 16, v24
    v_lshl_or_b32 v31, v27, 16, v26
    s_add_u32 s36, s23, 2359296
    buffer_store_dwordx4 v[28:31], v14, s[24:27], s36 offen sc0 sc1
L_a_wt_done:
    s_mov_b64 exec, s[30:31]
L_phA_done:
    s_waitcnt vmcnt(0)
L_phA_done2:
    s_load_dwordx2 s[4:5], s[0:1], 32
    s_load_dwordx2 s[6:7], s[0:1], 40
    s_load_dwordx2 s[42:43], s[0:1], 72
    s_waitcnt lgkmcnt(0)
    s_barrier
    s_cmp_lg_u32 s33, 0
    s_cbranch_scc1 L_nf_1
    s_lshl_b32 s51, s2, 7
    s_add_u32 s51, s51, 0
    v_mov_b32 v244, 1
    v_mov_b32 v245, 0
    s_mov_b64 s[30:31], exec
    s_mov_b64 exec, 1
    buffer_store_dword v244, v245, s[56:59], s51 offen sc0 sc1
    s_mov_b64 exec, s[30:31]
L_nf_1:
    s_cmp_lt_u32 s2, 253
    s_cbranch_scc1 L_b_busy
    s_cmp_lg_u32 s33, 7
    s_cbranch_scc1 L_b_go_i
    s_load_dwordx2 s[90:91], s[0:1], 72
    s_waitcnt lgkmcnt(0)
    s_mov_b32 s92, s90
    s_mov_b32 s93, s91
    s_mov_b32 s94, 256
    s_mov_b32 s95, 0x00020000
    v_mov_b32 v245, 0
    s_mov_b32 s50, 400000
L_poll_z0_i:
    buffer_load_dword v244, v245, s[92:95], 0 offen sc0 sc1
    s_waitcnt vmcnt(0)
    v_readfirstlane_b32 s51, v244
    s_sub_u32 s50, s50, 1
    s_cmp_eq_u32 s50, 0
    s_cbranch_scc1 L_pollx_z0_i
    s_cmp_ge_u32 s51, 256
    s_cbranch_scc1 L_pollx_z0_i
    s_sleep 2
    s_branch L_poll_z0_i
L_pollx_z0_i:
    v_mov_b32 v252, 0
    v_mov_b32 v253, 0
    v_mov_b32 v254, 0
    v_mov_b32 v255, 0
    v_lshlrev_b32 v248, 7, v2
    s_mov_b32 s50, 400000
L_poll_a_i:
    s_mov_b32 s51, 0
    buffer_load_dword v244, v248, s[56:59], s51 offen sc0 sc1
    s_mov_b32 s51, 8192
    buffer_load_dword v245, v248, s[56:59], s51 offen sc0 sc1
    s_mov_b32 s51, 16384
    buffer_load_dword v246, v248, s[56:59], s51 offen sc0 sc1
    s_mov_b32 s51, 24576
    buffer_load_dword v247, v248, s[56:59], s51 offen sc0 sc1
    s_waitcnt vmcnt(0)
    v_or_b32 v244, v244, v252
    v_or_b32 v245, v245, v253
    v_min_u32 v244, v244, v245
    v_or_b32 v246, v246, v254
    v_min_u32 v244, v244, v246
    v_or_b32 v247, v247, v255
    v_min_u32 v244, v244, v247
    v_cmp_eq_u32 vcc, 0, v244
    s_sub_u32 s50, s50, 1
    s_cmp_eq_u32 s50, 0
    s_cbranch_scc1 L_pollx_a_i
    s_cmp_eq_u64 vcc, 0
    s_cbranch_scc1 L_pollx_a_i
    s_sleep 2
    s_branch L_poll_a_i
L_pollx_a_i:
L_b_go_i:
    s_barrier
    s_branch L_phB_done
L_b_busy:
    s_cmp_ge_u32 s2, 216
    s_cbranch_scc1 L_k2_fft
    s_mov_b32 s12, s4
    s_mov_b32 s13, s5
    s_mov_b32 s14, 18874368
    s_mov_b32 s15, 0x00020000
    s_mov_b32 s16, s8
    s_mov_b32 s17, s9
    s_mov_b32 s18, 2359296
    s_mov_b32 s19, 0x00020000
    s_add_u32 s20, s8, 4194304
    s_addc_u32 s21, s9, 0
    s_mov_b32 s22, 5308416
    s_mov_b32 s23, 0x00020000
    s_mov_b32 s24, s6
    s_mov_b32 s25, s7
    s_mov_b32 s26, 9216
    s_mov_b32 s27, 0x00020000
    s_and_b32 s28, s2, 7
    s_lshr_b32 s29, s2, 3
    s_mul_i32 s28, s28, 27
    s_add_u32 s28, s28, s29
    s_mul_i32 s29, s28, 171
    s_lshr_b32 s29, s29, 10
    s_mul_i32 s30, s29, 6
    s_sub_u32 s30, s28, s30
    s_lshl_b32 s31, s29, 8
    s_mul_i32 s32, s30, 1536
    s_and_b32 s34, s33, 3
    s_lshr_b32 s35, s33, 2
    s_and_b32 s36, s34, 1
    s_lshr_b32 s37, s34, 1
    v_lshrrev_b32 v3, 4, v2
    v_and_b32 v4, 15, v2
    v_lshrrev_b32 v5, 2, v4
    v_and_b32 v6, 3, v4
    s_cmp_eq_u32 s35, 0
    s_cbranch_scc1 L_g1_compute
    s_lshl_b32 s38, s34, 4
    v_add_u32 v9, s38, v3
    s_mov_b32 s39, 9216
    v_mul_lo_u32 v9, v9, s39
    v_add_u32 v9, s31, v9
    v_lshlrev_b32 v10, 1, v3
    v_xor_b32 v11, v10, v4
    v_lshlrev_b32 v11, 4, v11
    v_add_u32 v20, v9, v11
    v_xor_b32 v11, 8, v10
    v_xor_b32 v11, v11, v4
    v_lshlrev_b32 v11, 4, v11
    v_add_u32 v21, v9, v11
    s_mul_i32 s38, s34, 192
    s_add_u32 s38, s38, 0
    v_add_u32 v9, s38, v2
    v_mul_u32_u24 v10, 683, v9
    v_lshrrev_b32 v10, 16, v10
    v_mul_u32_u24 v11, 96, v10
    v_sub_u32 v11, v9, v11
    v_mul_u32_u24 v10, 9216, v10
    v_lshlrev_b32 v11, 4, v11
    v_add_u32 v10, v10, v11
    s_mov_b32 s38, s32
    v_add_u32 v22, s38, v10
    s_mul_i32 s38, s34, 192
    s_add_u32 s38, s38, 64
    v_add_u32 v9, s38, v2
    v_mul_u32_u24 v10, 683, v9
    v_lshrrev_b32 v10, 16, v10
    v_mul_u32_u24 v11, 96, v10
    v_sub_u32 v11, v9, v11
    v_mul_u32_u24 v10, 9216, v10
    v_lshlrev_b32 v11, 4, v11
    v_add_u32 v10, v10, v11
    s_sub_u32 s38, s32, 1024
    v_add_u32 v23, s38, v10
    s_mul_i32 s38, s34, 192
    s_add_u32 s38, s38, 128
    v_add_u32 v9, s38, v2
    v_mul_u32_u24 v10, 683, v9
    v_lshrrev_b32 v10, 16, v10
    v_mul_u32_u24 v11, 96, v10
    v_sub_u32 v11, v9, v11
    v_mul_u32_u24 v10, 9216, v10
    v_lshlrev_b32 v11, 4, v11
    v_add_u32 v10, v10, v11
    s_sub_u32 s38, s32, 2048
    v_add_u32 v24, s38, v10
    s_lshl_b32 s43, s34, 12
    s_mul_i32 s46, s34, 3072
    s_add_u32 s46, s46, 16384
    s_mov_b32 s47, 0
    s_mov_b32 s42, 0
    s_lshl_b32 s38, s30, 5
    s_mul_i32 s38, s38, 171
    s_lshr_b32 s38, s38, 10
    s_mul_i32 s42, s38, 589824
    s_mul_i32 s47, s38, 73728
    s_mov_b32 s40, 0
    s_add_u32 m0, s40, s43
    s_add_u32 s44, s42, 0
    buffer_load_dwordx4 v20, s[12:15], s44 offen offset:0 lds
    s_add_u32 s44, s42, 35840
    buffer_load_dwordx4 v20, s[12:15], s44 offen offset:1024 lds
    s_add_u32 s44, s42, 71680
    buffer_load_dwordx4 v21, s[12:15], s44 offen offset:2048 lds
    s_add_u32 s44, s42, 107520
    buffer_load_dwordx4 v21, s[12:15], s44 offen offset:3072 lds
    s_add_u32 s42, s42, 589824
    s_cmp_eq_u32 s42, 18874368
    s_cselect_b32 s42, 0, s42
    s_mov_b32 s40, 28672
    s_add_u32 m0, s40, s43
    s_add_u32 s44, s42, 0
    buffer_load_dwordx4 v20, s[12:15], s44 offen offset:0 lds
    s_add_u32 s44, s42, 35840
    buffer_load_dwordx4 v20, s[12:15], s44 offen offset:1024 lds
    s_add_u32 s44, s42, 71680
    buffer_load_dwordx4 v21, s[12:15], s44 offen offset:2048 lds
    s_add_u32 s44, s42, 107520
    buffer_load_dwordx4 v21, s[12:15], s44 offen offset:3072 lds
    s_add_u32 s42, s42, 589824
    s_cmp_eq_u32 s42, 18874368
    s_cselect_b32 s42, 0, s42
    s_mov_b32 s40, 57344
    s_add_u32 m0, s40, s43
    s_add_u32 s44, s42, 0
    buffer_load_dwordx4 v20, s[12:15], s44 offen offset:0 lds
    s_add_u32 s44, s42, 35840
    buffer_load_dwordx4 v20, s[12:15], s44 offen offset:1024 lds
    s_add_u32 s44, s42, 71680
    buffer_load_dwordx4 v21, s[12:15], s44 offen offset:2048 lds
    s_add_u32 s44, s42, 107520
    buffer_load_dwordx4 v21, s[12:15], s44 offen offset:3072 lds
    s_add_u32 s42, s42, 589824
    s_cmp_eq_u32 s42, 18874368
    s_cselect_b32 s42, 0, s42
    s_mov_b32 s40, 86016
    s_add_u32 m0, s40, s43
    s_add_u32 s44, s42, 0
    buffer_load_dwordx4 v20, s[12:15], s44 offen offset:0 lds
    s_add_u32 s44, s42, 35840
    buffer_load_dwordx4 v20, s[12:15], s44 offen offset:1024 lds
    s_add_u32 s44, s42, 71680
    buffer_load_dwordx4 v21, s[12:15], s44 offen offset:2048 lds
    s_add_u32 s44, s42, 107520
    buffer_load_dwordx4 v21, s[12:15], s44 offen offset:3072 lds
    s_add_u32 s42, s42, 589824
    s_cmp_eq_u32 s42, 18874368
    s_cselect_b32 s42, 0, s42
    s_mov_b32 s40, 114688
    s_add_u32 m0, s40, s43
    s_add_u32 s44, s42, 0
    buffer_load_dwordx4 v20, s[12:15], s44 offen offset:0 lds
    s_add_u32 s44, s42, 35840
    buffer_load_dwordx4 v20, s[12:15], s44 offen offset:1024 lds
    s_add_u32 s44, s42, 71680
    buffer_load_dwordx4 v21, s[12:15], s44 offen offset:2048 lds
    s_add_u32 s44, s42, 107520
    buffer_load_dwordx4 v21, s[12:15], s44 offen offset:3072 lds
    s_add_u32 s42, s42, 589824
    s_cmp_eq_u32 s42, 18874368
    s_cselect_b32 s42, 0, s42
    s_cmp_lg_u32 s33, 7
    s_cbranch_scc1 L_b_go_g1
    s_load_dwordx2 s[90:91], s[0:1], 72
    s_waitcnt lgkmcnt(0)
    s_mov_b32 s92, s90
    s_mov_b32 s93, s91
    s_mov_b32 s94, 256
    s_mov_b32 s95, 0x00020000
    v_mov_b32 v245, 0
    s_mov_b32 s50, 400000
L_poll_z0_g1:
    buffer_load_dword v244, v245, s[92:95], 0 offen sc0 sc1
    s_waitcnt vmcnt(0)
    v_readfirstlane_b32 s51, v244
    s_sub_u32 s50, s50, 1
    s_cmp_eq_u32 s50, 0
    s_cbranch_scc1 L_pollx_z0_g1
    s_cmp_ge_u32 s51, 256
    s_cbranch_scc1 L_pollx_z0_g1
    s_sleep 2
    s_branch L_poll_z0_g1
L_pollx_z0_g1:
    v_mov_b32 v252, 0
    v_mov_b32 v253, 0
    v_mov_b32 v254, 0
    v_mov_b32 v255, 0
    v_lshlrev_b32 v248, 7, v2
    s_mov_b32 s50, 400000
L_poll_a_g1:
    s_mov_b32 s51, 0
    buffer_load_dword v244, v248, s[56:59], s51 offen sc0 sc1
    s_mov_b32 s51, 8192
    buffer_load_dword v245, v248, s[56:59], s51 offen sc0 sc1
    s_mov_b32 s51, 16384
    buffer_load_dword v246, v248, s[56:59], s51 offen sc0 sc1
    s_mov_b32 s51, 24576
    buffer_load_dword v247, v248, s[56:59], s51 offen sc0 sc1
    s_waitcnt vmcnt(0)
    v_or_b32 v244, v244, v252
    v_or_b32 v245, v245, v253
    v_min_u32 v244, v244, v245
    v_or_b32 v246, v246, v254
    v_min_u32 v244, v244, v246
    v_or_b32 v247, v247, v255
    v_min_u32 v244, v244, v247
    v_cmp_eq_u32 vcc, 0, v244
    s_sub_u32 s50, s50, 1
    s_cmp_eq_u32 s50, 0
    s_cbranch_scc1 L_pollx_a_g1
    s_cmp_eq_u64 vcc, 0
    s_cbranch_scc1 L_pollx_a_g1
    s_sleep 2
    s_branch L_poll_a_g1
L_pollx_a_g1:
L_b_go_g1:
    s_barrier
    s_mov_b32 s40, 0
    s_add_u32 m0, s40, s46
    s_nop 0
    buffer_load_dwordx4 v22, s[16:19], s47 offen offset:0 lds
    buffer_load_dwordx4 v23, s[16:19], s47 offen offset:1024 lds
    buffer_load_dwordx4 v24, s[16:19], s47 offen offset:2048 lds
    s_add_u32 s47, s47, 73728
    s_cmp_eq_u32 s47, 2359296
    s_cselect_b32 s47, 0, s47
    s_mov_b32 s40, 28672
    s_add_u32 m0, s40, s46
    s_nop 0
    buffer_load_dwordx4 v22, s[16:19], s47 offen offset:0 lds
    buffer_load_dwordx4 v23, s[16:19], s47 offen offset:1024 lds
    buffer_load_dwordx4 v24, s[16:19], s47 offen offset:2048 lds
    s_add_u32 s47, s47, 73728
    s_cmp_eq_u32 s47, 2359296
    s_cselect_b32 s47, 0, s47
    s_mov_b32 s40, 57344
    s_add_u32 m0, s40, s46
    s_nop 0
    buffer_load_dwordx4 v22, s[16:19], s47 offen offset:0 lds
    buffer_load_dwordx4 v23, s[16:19], s47 offen offset:1024 lds
    buffer_load_dwordx4 v24, s[16:19], s47 offen offset:2048 lds
    s_add_u32 s47, s47, 73728
    s_cmp_eq_u32 s47, 2359296
    s_cselect_b32 s47, 0, s47
    s_mov_b32 s40, 86016
    s_add_u32 m0, s40, s46
    s_nop 0
    buffer_load_dwordx4 v22, s[16:19], s47 offen offset:0 lds
    buffer_load_dwordx4 v23, s[16:19], s47 offen offset:1024 lds
    buffer_load_dwordx4 v24, s[16:19], s47 offen offset:2048 lds
    s_add_u32 s47, s47, 73728
    s_cmp_eq_u32 s47, 2359296
    s_cselect_b32 s47, 0, s47
    s_mov_b32 s40, 114688
    s_add_u32 m0, s40, s46
    s_nop 0
    buffer_load_dwordx4 v22, s[16:19], s47 offen offset:0 lds
    buffer_load_dwordx4 v23, s[16:19], s47 offen offset:1024 lds
    buffer_load_dwordx4 v24, s[16:19], s47 offen offset:2048 lds
    s_add_u32 s47, s47, 73728
    s_cmp_eq_u32 s47, 2359296
    s_cselect_b32 s47, 0, s47
    s_waitcnt vmcnt(12)
    s_barrier
    s_mov_b32 s40, 0
    s_waitcnt vmcnt(9)
    s_barrier
    s_add_u32 m0, s40, s43
    s_add_u32 s44, s42, 0
    buffer_load_dwordx4 v20, s[12:15], s44 offen offset:0 lds
    s_add_u32 s44, s42, 35840
    buffer_load_dwordx4 v20, s[12:15], s44 offen offset:1024 lds
    s_add_u32 s44, s42, 71680
    buffer_load_dwordx4 v21, s[12:15], s44 offen offset:2048 lds
    s_add_u32 s44, s42, 107520
    buffer_load_dwordx4 v21, s[12:15], s44 offen offset:3072 lds
    s_add_u32 s42, s42, 589824
    s_cmp_eq_u32 s42, 18874368
    s_cselect_b32 s42, 0, s42
    s_add_u32 m0, s40, s46
    s_nop 0
    buffer_load_dwordx4 v22, s[16:19], s47 offen offset:0 lds
    buffer_load_dwordx4 v23, s[16:19], s47 offen offset:1024 lds
    buffer_load_dwordx4 v24, s[16:19], s47 offen offset:2048 lds
    s_add_u32 s47, s47, 73728
    s_cmp_eq_u32 s47, 2359296
    s_cselect_b32 s47, 0, s47
    s_add_u32 s40, s40, 28672
    s_cmp_eq_u32 s40, 143360
    s_cselect_b32 s40, 0, s40
    s_waitcnt vmcnt(13)
    s_barrier
    s_add_u32 m0, s40, s43
    s_add_u32 s44, s42, 0
    buffer_load_dwordx4 v20, s[12:15], s44 offen offset:0 lds
    s_add_u32 s44, s42, 35840
    buffer_load_dwordx4 v20, s[12:15], s44 offen offset:1024 lds
    s_add_u32 s44, s42, 71680
    buffer_load_dwordx4 v21, s[12:15], s44 offen offset:2048 lds
    s_add_u32 s44, s42, 107520
    buffer_load_dwordx4 v21, s[12:15], s44 offen offset:3072 lds
    s_add_u32 s42, s42, 589824
    s_cmp_eq_u32 s42, 18874368
    s_cselect_b32 s42, 0, s42
    s_add_u32 m0, s40, s46
    s_nop 0
    buffer_load_dwordx4 v22, s[16:19], s47 offen offset:0 lds
    buffer_load_dwordx4 v23, s[16:19], s47 offen offset:1024 lds
    buffer_load_dwordx4 v24, s[16:19], s47 offen offset:2048 lds
    s_add_u32 s47, s47, 73728
    s_cmp_eq_u32 s47, 2359296
    s_cselect_b32 s47, 0, s47
    s_add_u32 s40, s40, 28672
    s_cmp_eq_u32 s40, 143360
    s_cselect_b32 s40, 0, s40
    s_waitcnt vmcnt(17)
    s_barrier
    s_add_u32 m0, s40, s43
    s_add_u32 s44, s42, 0
    buffer_load_dwordx4 v20, s[12:15], s44 offen offset:0 lds
    s_add_u32 s44, s42, 35840
    buffer_load_dwordx4 v20, s[12:15], s44 offen offset:1024 lds
    s_add_u32 s44, s42, 71680
    buffer_load_dwordx4 v21, s[12:15], s44 offen offset:2048 lds
    s_add_u32 s44, s42, 107520
    buffer_load_dwordx4 v21, s[12:15], s44 offen offset:3072 lds
    s_add_u32 s42, s42, 589824
    s_cmp_eq_u32 s42, 18874368
    s_cselect_b32 s42, 0, s42
    s_add_u32 m0, s40, s46
    s_nop 0
    buffer_load_dwordx4 v22, s[16:19], s47 offen offset:0 lds
    buffer_load_dwordx4 v23, s[16:19], s47 offen offset:1024 lds
    buffer_load_dwordx4 v24, s[16:19], s47 offen offset:2048 lds
    s_add_u32 s47, s47, 73728
    s_cmp_eq_u32 s47, 2359296
    s_cselect_b32 s47, 0, s47
    s_add_u32 s40, s40, 28672
    s_cmp_eq_u32 s40, 143360
    s_cselect_b32 s40, 0, s40
    s_mov_b32 s45, 24
L_g1_ld:
    s_waitcnt vmcnt(21)
    s_barrier
    s_add_u32 m0, s40, s43
    s_add_u32 s44, s42, 0
    buffer_load_dwordx4 v20, s[12:15], s44 offen offset:0 lds
    s_add_u32 s44, s42, 35840
    buffer_load_dwordx4 v20, s[12:15], s44 offen offset:1024 lds
    s_add_u32 s44, s42, 71680
    buffer_load_dwordx4 v21, s[12:15], s44 offen offset:2048 lds
    s_add_u32 s44, s42, 107520
    buffer_load_dwordx4 v21, s[12:15], s44 offen offset:3072 lds
    s_add_u32 s42, s42, 589824
    s_cmp_eq_u32 s42, 18874368
    s_cselect_b32 s42, 0, s42
    s_add_u32 m0, s40, s46
    s_nop 0
    buffer_load_dwordx4 v22, s[16:19], s47 offen offset:0 lds
    buffer_load_dwordx4 v23, s[16:19], s47 offen offset:1024 lds
    buffer_load_dwordx4 v24, s[16:19], s47 offen offset:2048 lds
    s_add_u32 s47, s47, 73728
    s_cmp_eq_u32 s47, 2359296
    s_cselect_b32 s47, 0, s47
    s_add_u32 s40, s40, 28672
    s_cmp_eq_u32 s40, 143360
    s_cselect_b32 s40, 0, s40
    s_sub_u32 s45, s45, 1
    s_cmp_lg_u32 s45, 0
    s_cbranch_scc1 L_g1_ld
    s_waitcnt vmcnt(21)
    s_barrier
    s_waitcnt vmcnt(14)
    s_barrier
    s_waitcnt vmcnt(7)
    s_barrier
    s_waitcnt vmcnt(0)
    s_barrier
    s_waitcnt vmcnt(0)
    s_barrier
    s_branch L_g1_epi_ld
L_g1_compute:
    v_and_b32 v7, 1, v3
    v_lshlrev_b32 v7, 2, v7
    v_or_b32 v7, v7, v5
    v_lshlrev_b32 v8, 3, v3
    v_add_u32 v8, v8, v5
    v_lshlrev_b32 v8, 8, v8
    v_lshlrev_b32 v9, 3, v6
    v_add_u32 v8, v8, v9
    s_lshl_b32 s38, s36, 2
    s_add_u32 s39, s38, 0
    v_xor_b32 v9, s39, v7
    v_lshlrev_b32 v9, 5, v9
    v_add_u32 v100, v8, v9
    s_add_u32 s39, s38, 1
    v_xor_b32 v9, s39, v7
    v_lshlrev_b32 v9, 5, v9
    v_add_u32 v101, v8, v9
    s_add_u32 s39, s38, 2
    v_xor_b32 v9, s39, v7
    v_lshlrev_b32 v9, 5, v9
    v_add_u32 v102, v8, v9
    s_add_u32 s39, s38, 3
    v_xor_b32 v9, s39, v7
    v_lshlrev_b32 v9, 5, v9
    v_add_u32 v103, v8, v9
    v_mul_u32_u24 v9, 96, v3
    s_mul_i32 s38, s37, 48
    v_add_u32 v9, s38, v9
    v_add_u32 v9, v9, v4
    v_lshlrev_b32 v9, 4, v9
    v_add_u32 v104, 16384, v9
    v_mov_b32 v16, 0
    v_mov_b32 v17, 0
    v_mov_b32 v18, 0
    v_mov_b32 v19, 0
    v_mov_b32 v20, 0
    v_mov_b32 v21, 0
    v_mov_b32 v22, 0
    v_mov_b32 v23, 0
    v_mov_b32 v24, 0
    v_mov_b32 v25, 0
    v_mov_b32 v26, 0
    v_mov_b32 v27, 0
    v_mov_b32 v28, 0
    v_mov_b32 v29, 0
    v_mov_b32 v30, 0
    v_mov_b32 v31, 0
    v_mov_b32 v32, 0
    v_mov_b32 v33, 0
    v_mov_b32 v34, 0
    v_mov_b32 v35, 0
    v_mov_b32 v36, 0
    v_mov_b32 v37, 0
    v_mov_b32 v38, 0
    v_mov_b32 v39, 0
    v_mov_b32 v40, 0
    v_mov_b32 v41, 0
    v_mov_b32 v42, 0
    v_mov_b32 v43, 0
    v_mov_b32 v44, 0
    v_mov_b32 v45, 0
    v_mov_b32 v46, 0
    v_mov_b32 v47, 0
    v_mov_b32 v48, 0
    v_mov_b32 v49, 0
    v_mov_b32 v50, 0
    v_mov_b32 v51, 0
    v_mov_b32 v52, 0
    v_mov_b32 v53, 0
    v_mov_b32 v54, 0
    v_mov_b32 v55, 0
    v_mov_b32 v56, 0
    v_mov_b32 v57, 0
    v_mov_b32 v58, 0
    v_mov_b32 v59, 0
    v_mov_b32 v60, 0
    v_mov_b32 v61, 0
    v_mov_b32 v62, 0
    v_mov_b32 v63, 0
    s_barrier
    s_barrier
    s_mov_b32 s41, 0
    v_add_u32 v105, s41, v100
    v_add_u32 v106, s41, v101
    v_add_u32 v107, s41, v102
    v_add_u32 v108, s41, v103
    v_add_u32 v109, s41, v104
    ds_read_b64_tr_b16 v[112:113], v105 offset:0
    ds_read_b64_tr_b16 v[114:115], v105 offset:1024
    ds_read_b64_tr_b16 v[116:117], v106 offset:0
    ds_read_b64_tr_b16 v[118:119], v106 offset:1024
    ds_read_b64_tr_b16 v[120:121], v107 offset:0
    ds_read_b64_tr_b16 v[122:123], v107 offset:1024
    ds_read_b64_tr_b16 v[124:125], v108 offset:0
    ds_read_b64_tr_b16 v[126:127], v108 offset:1024
    ds_read_b128 v[128:131], v109 offset:0
    ds_read_b128 v[132:135], v109 offset:256
    ds_read_b128 v[136:139], v109 offset:512
    s_mov_b32 s45, 31
L_g1_cp:
    s_waitcnt lgkmcnt(0)
    v_mfma_f32_16x16x32_bf16 v[16:19], v[112:115], v[128:131], v[16:19]
    ds_read_b64_tr_b16 v[140:141], v105 offset:8192
    ds_read_b64_tr_b16 v[142:143], v105 offset:9216
    v_mfma_f32_16x16x32_bf16 v[28:31], v[116:119], v[128:131], v[28:31]
    ds_read_b64_tr_b16 v[144:145], v106 offset:8192
    ds_read_b64_tr_b16 v[146:147], v106 offset:9216
    v_mfma_f32_16x16x32_bf16 v[40:43], v[120:123], v[128:131], v[40:43]
    ds_read_b64_tr_b16 v[148:149], v107 offset:8192
    ds_read_b64_tr_b16 v[150:151], v107 offset:9216
    v_mfma_f32_16x16x32_bf16 v[52:55], v[124:127], v[128:131], v[52:55]
    ds_read_b64_tr_b16 v[152:153], v108 offset:8192
    ds_read_b64_tr_b16 v[154:155], v108 offset:9216
    v_mfma_f32_16x16x32_bf16 v[20:23], v[112:115], v[132:135], v[20:23]
    ds_read_b128 v[156:159], v109 offset:6144
    ds_read_b128 v[160:163], v109 offset:6400
    v_mfma_f32_16x16x32_bf16 v[32:35], v[116:119], v[132:135], v[32:35]
    ds_read_b128 v[164:167], v109 offset:6656
    v_mfma_f32_16x16x32_bf16 v[44:47], v[120:123], v[132:135], v[44:47]
    v_mfma_f32_16x16x32_bf16 v[56:59], v[124:127], v[132:135], v[56:59]
    v_mfma_f32_16x16x32_bf16 v[24:27], v[112:115], v[136:139], v[24:27]
    v_mfma_f32_16x16x32_bf16 v[36:39], v[116:119], v[136:139], v[36:39]
    v_mfma_f32_16x16x32_bf16 v[48:51], v[120:123], v[136:139], v[48:51]
    v_mfma_f32_16x16x32_bf16 v[60:63], v[124:127], v[136:139], v[60:63]
    s_add_u32 s41, s41, 28672
    s_cmp_eq_u32 s41, 143360
    s_cselect_b32 s41, 0, s41
    v_add_u32 v105, s41, v100
    v_add_u32 v106, s41, v101
    v_add_u32 v107, s41, v102
    v_add_u32 v108, s41, v103
    v_add_u32 v109, s41, v104
    s_waitcnt lgkmcnt(0)
    s_barrier
    v_mfma_f32_16x16x32_bf16 v[16:19], v[140:143], v[156:159], v[16:19]
    ds_read_b64_tr_b16 v[112:113], v105 offset:0
    ds_read_b64_tr_b16 v[114:115], v105 offset:1024
    v_mfma_f32_16x16x32_bf16 v[28:31], v[144:147], v[156:159], v[28:31]
    ds_read_b64_tr_b16 v[116:117], v106 offset:0
    ds_read_b64_tr_b16 v[118:119], v106 offset:1024
    v_mfma_f32_16x16x32_bf16 v[40:43], v[148:151], v[156:159], v[40:43]
    ds_read_b64_tr_b16 v[120:121], v107 offset:0
    ds_read_b64_tr_b16 v[122:123], v107 offset:1024
    v_mfma_f32_16x16x32_bf16 v[52:55], v[152:155], v[156:159], v[52:55]
    ds_read_b64_tr_b16 v[124:125], v108 offset:0
    ds_read_b64_tr_b16 v[126:127], v108 offset:1024
    v_mfma_f32_16x16x32_bf16 v[20:23], v[140:143], v[160:163], v[20:23]
    ds_read_b128 v[128:131], v109 offset:0
    ds_read_b128 v[132:135], v109 offset:256
    v_mfma_f32_16x16x32_bf16 v[32:35], v[144:147], v[160:163], v[32:35]
    ds_read_b128 v[136:139], v109 offset:512
    v_mfma_f32_16x16x32_bf16 v[44:47], v[148:151], v[160:163], v[44:47]
    v_mfma_f32_16x16x32_bf16 v[56:59], v[152:155], v[160:163], v[56:59]
    v_mfma_f32_16x16x32_bf16 v[24:27], v[140:143], v[164:167], v[24:27]
    v_mfma_f32_16x16x32_bf16 v[36:39], v[144:147], v[164:167], v[36:39]
    v_mfma_f32_16x16x32_bf16 v[48:51], v[148:151], v[164:167], v[48:51]
    v_mfma_f32_16x16x32_bf16 v[60:63], v[152:155], v[164:167], v[60:63]
    s_sub_u32 s45, s45, 1
    s_cmp_lg_u32 s45, 0
    s_cbranch_scc1 L_g1_cp
    s_waitcnt lgkmcnt(0)
    v_mfma_f32_16x16x32_bf16 v[16:19], v[112:115], v[128:131], v[16:19]
    ds_read_b64_tr_b16 v[140:141], v105 offset:8192
    ds_read_b64_tr_b16 v[142:143], v105 offset:9216
    v_mfma_f32_16x16x32_bf16 v[28:31], v[116:119], v[128:131], v[28:31]
    ds_read_b64_tr_b16 v[144:145], v106 offset:8192
    ds_read_b64_tr_b16 v[146:147], v106 offset:9216
    v_mfma_f32_16x16x32_bf16 v[40:43], v[120:123], v[128:131], v[40:43]
    ds_read_b64_tr_b16 v[148:149], v107 offset:8192
    ds_read_b64_tr_b16 v[150:151], v107 offset:9216
    v_mfma_f32_16x16x32_bf16 v[52:55], v[124:127], v[128:131], v[52:55]
    ds_read_b64_tr_b16 v[152:153], v108 offset:8192
    ds_read_b64_tr_b16 v[154:155], v108 offset:9216
    v_mfma_f32_16x16x32_bf16 v[20:23], v[112:115], v[132:135], v[20:23]
    ds_read_b128 v[156:159], v109 offset:6144
    ds_read_b128 v[160:163], v109 offset:6400
    v_mfma_f32_16x16x32_bf16 v[32:35], v[116:119], v[132:135], v[32:35]
    ds_read_b128 v[164:167], v109 offset:6656
    v_mfma_f32_16x16x32_bf16 v[44:47], v[120:123], v[132:135], v[44:47]
    v_mfma_f32_16x16x32_bf16 v[56:59], v[124:127], v[132:135], v[56:59]
    v_mfma_f32_16x16x32_bf16 v[24:27], v[112:115], v[136:139], v[24:27]
    v_mfma_f32_16x16x32_bf16 v[36:39], v[116:119], v[136:139], v[36:39]
    v_mfma_f32_16x16x32_bf16 v[48:51], v[120:123], v[136:139], v[48:51]
    v_mfma_f32_16x16x32_bf16 v[60:63], v[124:127], v[136:139], v[60:63]
    s_waitcnt lgkmcnt(0)
    s_barrier
    v_mfma_f32_16x16x32_bf16 v[16:19], v[140:143], v[156:159], v[16:19]
    v_mfma_f32_16x16x32_bf16 v[28:31], v[144:147], v[156:159], v[28:31]
    v_mfma_f32_16x16x32_bf16 v[40:43], v[148:151], v[156:159], v[40:43]
    v_mfma_f32_16x16x32_bf16 v[52:55], v[152:155], v[156:159], v[52:55]
    v_mfma_f32_16x16x32_bf16 v[20:23], v[140:143], v[160:163], v[20:23]
    v_mfma_f32_16x16x32_bf16 v[32:35], v[144:147], v[160:163], v[32:35]
    v_mfma_f32_16x16x32_bf16 v[44:47], v[148:151], v[160:163], v[44:47]
    v_mfma_f32_16x16x32_bf16 v[56:59], v[152:155], v[160:163], v[56:59]
    v_mfma_f32_16x16x32_bf16 v[24:27], v[140:143], v[164:167], v[24:27]
    v_mfma_f32_16x16x32_bf16 v[36:39], v[144:147], v[164:167], v[36:39]
    v_mfma_f32_16x16x32_bf16 v[48:51], v[148:151], v[164:167], v[48:51]
    v_mfma_f32_16x16x32_bf16 v[60:63], v[152:155], v[164:167], v[60:63]
    v_lshlrev_b32 v9, 4, v2
    s_mul_i32 s38, s34, 6144
    v_add_u32 v10, s38, v9
    s_nop 4
    ds_write_b128 v10, v[40:43] offset:0
    ds_write_b128 v10, v[44:47] offset:1024
    ds_write_b128 v10, v[48:51] offset:2048
    ds_write_b128 v10, v[52:55] offset:3072
    ds_write_b128 v10, v[56:59] offset:4096
    ds_write_b128 v10, v[60:63] offset:5120
    s_branch L_g1_epi
L_g1_epi_ld:
    v_lshlrev_b32 v9, 4, v2
    s_mul_i32 s38, s34, 6144
    v_add_u32 v10, s38, v9
L_g1_epi:
    s_lshl_b32 s38, s36, 7
    s_add_u32 s38, s38, s31
    s_lshl_b32 s39, s35, 6
    s_add_u32 s38, s38, s39
    v_lshlrev_b32 v12, 3, v3
    buffer_load_dwordx2 v[64:65], v12, s[24:27], s38 offen offset:0
    buffer_load_dwordx2 v[66:67], v12, s[24:27], s38 offen offset:32
    s_mov_b32 s46, 0xc0135761
    s_mov_b32 s47, 0xbdd2d3e8
    v_mov_b32 v102, s46
    s_lshl_b32 s38, s29, 4
    s_lshl_b32 s39, s36, 3
    s_add_u32 s38, s38, s39
    s_lshl_b32 s39, s35, 2
    s_add_u32 s38, s38, s39
    v_lshrrev_b32 v12, 1, v3
    v_add_u32 v12, s38, v12
    v_mul_u32_u24 v12, 576, v12
    s_mul_i32 s38, s37, 48
    v_add_u32 v12, s38, v12
    v_add_u32 v12, v12, v4
    v_lshlrev_b32 v12, 4, v12
    v_add_u32 v12, s32, v12
    v_and_b32 v13, 1, v3
    v_lshlrev_b32 v13, 3, v13
    v_add_u32 v12, v12, v13
    s_waitcnt lgkmcnt(0)
    s_barrier
    s_cmp_eq_u32 s35, 0
    s_cbranch_scc1 L_g1_epi2
    ds_read_b128 v[16:19], v10 offset:0
    ds_read_b128 v[20:23], v10 offset:1024
    ds_read_b128 v[24:27], v10 offset:2048
    ds_read_b128 v[28:31], v10 offset:3072
    ds_read_b128 v[32:35], v10 offset:4096
    ds_read_b128 v[36:39], v10 offset:5120
L_g1_epi2:
    s_waitcnt vmcnt(0) lgkmcnt(0)
    v_lshlrev_b32 v80, 16, v64
    v_and_b32 v81, 0xffff0000, v64
    v_lshlrev_b32 v82, 16, v65
    v_and_b32 v83, 0xffff0000, v65
    v_lshlrev_b32 v84, 16, v66
    v_and_b32 v85, 0xffff0000, v66
    v_lshlrev_b32 v86, 16, v67
    v_and_b32 v87, 0xffff0000, v67
    v_cvt_pk_bf16_f32 v64, v16, v17
    v_lshlrev_b32 v16, 16, v64
    v_and_b32 v17, 0xffff0000, v64
    v_add_f32 v16, v16, v80
    v_add_f32 v17, v17, v81
    v_cvt_pk_bf16_f32 v65, v16, v17
    v_lshlrev_b32 v16, 16, v65
    v_and_b32 v17, 0xffff0000, v65
    v_cvt_pk_bf16_f32 v64, v18, v19
    v_lshlrev_b32 v18, 16, v64
    v_and_b32 v19, 0xffff0000, v64
    v_add_f32 v18, v18, v82
    v_add_f32 v19, v19, v83
    v_cvt_pk_bf16_f32 v65, v18, v19
    v_lshlrev_b32 v18, 16, v65
    v_and_b32 v19, 0xffff0000, v65
    v_mul_f32 v66, v16, v16
    v_fma_f32 v66, v66, s47, v102
    v_mul_f32 v66, v66, v16
    v_exp_f32 v66, v66
    v_mul_f32 v67, v17, v17
    v_fma_f32 v67, v67, s47, v102
    v_mul_f32 v67, v67, v17
    v_exp_f32 v67, v67
    v_mul_f32 v68, v18, v18
    v_fma_f32 v68, v68, s47, v102
    v_mul_f32 v68, v68, v18
    v_exp_f32 v68, v68
    v_mul_f32 v69, v19, v19
    v_fma_f32 v69, v69, s47, v102
    v_mul_f32 v69, v69, v19
    v_exp_f32 v69, v69
    v_add_f32 v66, 1.0, v66
    v_rcp_f32 v66, v66
    v_add_f32 v67, 1.0, v67
    v_rcp_f32 v67, v67
    v_add_f32 v68, 1.0, v68
    v_rcp_f32 v68, v68
    v_add_f32 v69, 1.0, v69
    v_rcp_f32 v69, v69
    s_nop 0
    v_mul_f32 v66, v66, v16
    v_mul_f32 v67, v67, v17
    v_mul_f32 v68, v68, v18
    v_mul_f32 v69, v69, v19
    v_cvt_pk_bf16_f32 v70, v66, v67
    v_cvt_pk_bf16_f32 v71, v68, v69
    s_mov_b32 s38, 0
    buffer_store_dwordx2 v[70:71], v12, s[20:23], s38 offen offset:0 sc0 sc1
    v_cvt_pk_bf16_f32 v64, v20, v21
    v_lshlrev_b32 v20, 16, v64
    v_and_b32 v21, 0xffff0000, v64
    v_add_f32 v20, v20, v80
    v_add_f32 v21, v21, v81
    v_cvt_pk_bf16_f32 v65, v20, v21
    v_lshlrev_b32 v20, 16, v65
    v_and_b32 v21, 0xffff0000, v65
    v_cvt_pk_bf16_f32 v64, v22, v23
    v_lshlrev_b32 v22, 16, v64
    v_and_b32 v23, 0xffff0000, v64
    v_add_f32 v22, v22, v82
    v_add_f32 v23, v23, v83
    v_cvt_pk_bf16_f32 v65, v22, v23
    v_lshlrev_b32 v22, 16, v65
    v_and_b32 v23, 0xffff0000, v65
    v_mul_f32 v66, v20, v20
    v_fma_f32 v66, v66, s47, v102
    v_mul_f32 v66, v66, v20
    v_exp_f32 v66, v66
    v_mul_f32 v67, v21, v21
    v_fma_f32 v67, v67, s47, v102
    v_mul_f32 v67, v67, v21
    v_exp_f32 v67, v67
    v_mul_f32 v68, v22, v22
    v_fma_f32 v68, v68, s47, v102
    v_mul_f32 v68, v68, v22
    v_exp_f32 v68, v68
    v_mul_f32 v69, v23, v23
    v_fma_f32 v69, v69, s47, v102
    v_mul_f32 v69, v69, v23
    v_exp_f32 v69, v69
    v_add_f32 v66, 1.0, v66
    v_rcp_f32 v66, v66
    v_add_f32 v67, 1.0, v67
    v_rcp_f32 v67, v67
    v_add_f32 v68, 1.0, v68
    v_rcp_f32 v68, v68
    v_add_f32 v69, 1.0, v69
    v_rcp_f32 v69, v69
    s_nop 0
    v_mul_f32 v66, v66, v20
    v_mul_f32 v67, v67, v21
    v_mul_f32 v68, v68, v22
    v_mul_f32 v69, v69, v23
    v_cvt_pk_bf16_f32 v72, v66, v67
    v_cvt_pk_bf16_f32 v73, v68, v69
    s_mov_b32 s38, 0
    buffer_store_dwordx2 v[72:73], v12, s[20:23], s38 offen offset:256 sc0 sc1
    v_cvt_pk_bf16_f32 v64, v24, v25
    v_lshlrev_b32 v24, 16, v64
    v_and_b32 v25, 0xffff0000, v64
    v_add_f32 v24, v24, v80
    v_add_f32 v25, v25, v81
    v_cvt_pk_bf16_f32 v65, v24, v25
    v_lshlrev_b32 v24, 16, v65
    v_and_b32 v25, 0xffff0000, v65
    v_cvt_pk_bf16_f32 v64, v26, v27
    v_lshlrev_b32 v26, 16, v64
    v_and_b32 v27, 0xffff0000, v64
    v_add_f32 v26, v26, v82
    v_add_f32 v27, v27, v83
    v_cvt_pk_bf16_f32 v65, v26, v27
    v_lshlrev_b32 v26, 16, v65
    v_and_b32 v27, 0xffff0000, v65
    v_mul_f32 v66, v24, v24
    v_fma_f32 v66, v66, s47, v102
    v_mul_f32 v66, v66, v24
    v_exp_f32 v66, v66
    v_mul_f32 v67, v25, v25
    v_fma_f32 v67, v67, s47, v102
    v_mul_f32 v67, v67, v25
    v_exp_f32 v67, v67
    v_mul_f32 v68, v26, v26
    v_fma_f32 v68, v68, s47, v102
    v_mul_f32 v68, v68, v26
    v_exp_f32 v68, v68
    v_mul_f32 v69, v27, v27
    v_fma_f32 v69, v69, s47, v102
    v_mul_f32 v69, v69, v27
    v_exp_f32 v69, v69
    v_add_f32 v66, 1.0, v66
    v_rcp_f32 v66, v66
    v_add_f32 v67, 1.0, v67
    v_rcp_f32 v67, v67
    v_add_f32 v68, 1.0, v68
    v_rcp_f32 v68, v68
    v_add_f32 v69, 1.0, v69
    v_rcp_f32 v69, v69
    s_nop 0
    v_mul_f32 v66, v66, v24
    v_mul_f32 v67, v67, v25
    v_mul_f32 v68, v68, v26
    v_mul_f32 v69, v69, v27
    v_cvt_pk_bf16_f32 v74, v66, v67
    v_cvt_pk_bf16_f32 v75, v68, v69
    s_mov_b32 s38, 0
    buffer_store_dwordx2 v[74:75], v12, s[20:23], s38 offen offset:512 sc0 sc1
    v_cvt_pk_bf16_f32 v64, v28, v29
    v_lshlrev_b32 v28, 16, v64
    v_and_b32 v29, 0xffff0000, v64
    v_add_f32 v28, v28, v84
    v_add_f32 v29, v29, v85
    v_cvt_pk_bf16_f32 v65, v28, v29
    v_lshlrev_b32 v28, 16, v65
    v_and_b32 v29, 0xffff0000, v65
    v_cvt_pk_bf16_f32 v64, v30, v31
    v_lshlrev_b32 v30, 16, v64
    v_and_b32 v31, 0xffff0000, v64
    v_add_f32 v30, v30, v86
    v_add_f32 v31, v31, v87
    v_cvt_pk_bf16_f32 v65, v30, v31
    v_lshlrev_b32 v30, 16, v65
    v_and_b32 v31, 0xffff0000, v65
    v_mul_f32 v66, v28, v28
    v_fma_f32 v66, v66, s47, v102
    v_mul_f32 v66, v66, v28
    v_exp_f32 v66, v66
    v_mul_f32 v67, v29, v29
    v_fma_f32 v67, v67, s47, v102
    v_mul_f32 v67, v67, v29
    v_exp_f32 v67, v67
    v_mul_f32 v68, v30, v30
    v_fma_f32 v68, v68, s47, v102
    v_mul_f32 v68, v68, v30
    v_exp_f32 v68, v68
    v_mul_f32 v69, v31, v31
    v_fma_f32 v69, v69, s47, v102
    v_mul_f32 v69, v69, v31
    v_exp_f32 v69, v69
    v_add_f32 v66, 1.0, v66
    v_rcp_f32 v66, v66
    v_add_f32 v67, 1.0, v67
    v_rcp_f32 v67, v67
    v_add_f32 v68, 1.0, v68
    v_rcp_f32 v68, v68
    v_add_f32 v69, 1.0, v69
    v_rcp_f32 v69, v69
    s_nop 0
    v_mul_f32 v66, v66, v28
    v_mul_f32 v67, v67, v29
    v_mul_f32 v68, v68, v30
    v_mul_f32 v69, v69, v31
    v_cvt_pk_bf16_f32 v76, v66, v67
    v_cvt_pk_bf16_f32 v77, v68, v69
    s_mov_b32 s38, 18432
    buffer_store_dwordx2 v[76:77], v12, s[20:23], s38 offen offset:0 sc0 sc1
    v_cvt_pk_bf16_f32 v64, v32, v33
    v_lshlrev_b32 v32, 16, v64
    v_and_b32 v33, 0xffff0000, v64
    v_add_f32 v32, v32, v84
    v_add_f32 v33, v33, v85
    v_cvt_pk_bf16_f32 v65, v32, v33
    v_lshlrev_b32 v32, 16, v65
    v_and_b32 v33, 0xffff0000, v65
    v_cvt_pk_bf16_f32 v64, v34, v35
    v_lshlrev_b32 v34, 16, v64
    v_and_b32 v35, 0xffff0000, v64
    v_add_f32 v34, v34, v86
    v_add_f32 v35, v35, v87
    v_cvt_pk_bf16_f32 v65, v34, v35
    v_lshlrev_b32 v34, 16, v65
    v_and_b32 v35, 0xffff0000, v65
    v_mul_f32 v66, v32, v32
    v_fma_f32 v66, v66, s47, v102
    v_mul_f32 v66, v66, v32
    v_exp_f32 v66, v66
    v_mul_f32 v67, v33, v33
    v_fma_f32 v67, v67, s47, v102
    v_mul_f32 v67, v67, v33
    v_exp_f32 v67, v67
    v_mul_f32 v68, v34, v34
    v_fma_f32 v68, v68, s47, v102
    v_mul_f32 v68, v68, v34
    v_exp_f32 v68, v68
    v_mul_f32 v69, v35, v35
    v_fma_f32 v69, v69, s47, v102
    v_mul_f32 v69, v69, v35
    v_exp_f32 v69, v69
    v_add_f32 v66, 1.0, v66
    v_rcp_f32 v66, v66
    v_add_f32 v67, 1.0, v67
    v_rcp_f32 v67, v67
    v_add_f32 v68, 1.0, v68
    v_rcp_f32 v68, v68
    v_add_f32 v69, 1.0, v69
    v_rcp_f32 v69, v69
    s_nop 0
    v_mul_f32 v66, v66, v32
    v_mul_f32 v67, v67, v33
    v_mul_f32 v68, v68, v34
    v_mul_f32 v69, v69, v35
    v_cvt_pk_bf16_f32 v70, v66, v67
    v_cvt_pk_bf16_f32 v71, v68, v69
    s_mov_b32 s38, 18432
    buffer_store_dwordx2 v[70:71], v12, s[20:23], s38 offen offset:256 sc0 sc1
    v_cvt_pk_bf16_f32 v64, v36, v37
    v_lshlrev_b32 v36, 16, v64
    v_and_b32 v37, 0xffff0000, v64
    v_add_f32 v36, v36, v84
    v_add_f32 v37, v37, v85
    v_cvt_pk_bf16_f32 v65, v36, v37
    v_lshlrev_b32 v36, 16, v65
    v_and_b32 v37, 0xffff0000, v65
    v_cvt_pk_bf16_f32 v64, v38, v39
    v_lshlrev_b32 v38, 16, v64
    v_and_b32 v39, 0xffff0000, v64
    v_add_f32 v38, v38, v86
    v_add_f32 v39, v39, v87
    v_cvt_pk_bf16_f32 v65, v38, v39
    v_lshlrev_b32 v38, 16, v65
    v_and_b32 v39, 0xffff0000, v65
    v_mul_f32 v66, v36, v36
    v_fma_f32 v66, v66, s47, v102
    v_mul_f32 v66, v66, v36
    v_exp_f32 v66, v66
    v_mul_f32 v67, v37, v37
    v_fma_f32 v67, v67, s47, v102
    v_mul_f32 v67, v67, v37
    v_exp_f32 v67, v67
    v_mul_f32 v68, v38, v38
    v_fma_f32 v68, v68, s47, v102
    v_mul_f32 v68, v68, v38
    v_exp_f32 v68, v68
    v_mul_f32 v69, v39, v39
    v_fma_f32 v69, v69, s47, v102
    v_mul_f32 v69, v69, v39
    v_exp_f32 v69, v69
    v_add_f32 v66, 1.0, v66
    v_rcp_f32 v66, v66
    v_add_f32 v67, 1.0, v67
    v_rcp_f32 v67, v67
    v_add_f32 v68, 1.0, v68
    v_rcp_f32 v68, v68
    v_add_f32 v69, 1.0, v69
    v_rcp_f32 v69, v69
    s_nop 0
    v_mul_f32 v66, v66, v36
    v_mul_f32 v67, v67, v37
    v_mul_f32 v68, v68, v38
    v_mul_f32 v69, v69, v39
    v_cvt_pk_bf16_f32 v72, v66, v67
    v_cvt_pk_bf16_f32 v73, v68, v69
    s_mov_b32 s38, 18432
    buffer_store_dwordx2 v[72:73], v12, s[20:23], s38 offen offset:512 sc0 sc1
    s_branch L_phB_done
    s_load_dwordx2 s[88:89], s[0:1], 48
    s_and_b32 s48, s2, 7
    s_lshr_b32 s49, s48, 1
    s_mul_i32 s49, s49, 1152
    s_and_b32 s48, s48, 1
    s_lshl_b32 s48, s48, 11
    s_lshr_b32 s50, s2, 3
    s_lshl_b32 s50, s50, 3
    s_add_u32 s50, s50, s33
    s_lshl_b32 s51, s50, 2
    s_add_u32 s49, s49, s51
    v_add_u32 v30, s49, v3
    v_lshlrev_b32 v30, 12, v30
    v_lshlrev_b32 v31, 7, v4
    v_add_u32 v30, v30, v31
    v_add_u32 v30, s48, v30
    s_waitcnt lgkmcnt(0)
    s_mov_b32 s92, s88
    s_mov_b32 s93, s89
    s_mov_b32 s94, 18874368
    s_mov_b32 s95, 0x00020000
    buffer_load_dword v110, v30, s[92:95], 0 offen
    s_mov_b32 s52, 0x7f000000
    s_cmp_lt_u32 s50, 72
    s_cselect_b32 s51, 3538944, s52
    buffer_load_dword v110, v30, s[92:95], s51 offen
    s_waitcnt vmcnt(2)
    s_branch L_phB_done2
L_k2_fft:
    s_add_u32 s12, s8, 50331648
    s_addc_u32 s13, s9, 0
    s_mov_b32 s14, 4751360
    s_mov_b32 s15, 0x00020000
    s_add_u32 s16, s8, 58720256
    s_addc_u32 s17, s9, 0
    s_mov_b32 s18, 2367488
    s_mov_b32 s19, 0x00020000
    s_add_u32 s20, s8, 67108864
    s_addc_u32 s21, s9, 0
    s_mov_b32 s22, 4751360
    s_mov_b32 s23, 0x00020000
    s_sub_u32 s28, s2, 216
    s_lshl_b32 s28, s28, 3
    s_add_u32 s28, s28, s33
    s_lshl_b32 s29, s28, 6
    v_lshrrev_b32 v14, 2, v2
    v_mul_u32_u24 v14, 18560, v14
    v_and_b32 v15, 3, v2
    v_lshlrev_b32 v15, 4, v15
    v_add_u32 v14, v14, v15
    s_lshl_b32 s30, s28, 13
    v_lshlrev_b32 v3, 4, v2
    v_lshlrev_b32 v4, 2, v2
    v_add_u32 v5, 0, v0
    v_lshrrev_b32 v6, 7, v5
    v_and_b32 v7, 127, v5
    v_mul_u32_u24 v6, v6, v7
    v_cvt_f32_u32 v6, v6
    v_mul_f32 v6, 0xba000000, v6
    v_cos_f32 v8, v6
    v_sin_f32 v9, v6
    v_lshlrev_b32 v5, 3, v5
    v_add_u32 v5, 139264, v5
    ds_write_b64 v5, v[8:9]
    v_add_u32 v5, 512, v0
    v_lshrrev_b32 v6, 7, v5
    v_and_b32 v7, 127, v5
    v_mul_u32_u24 v6, v6, v7
    v_cvt_f32_u32 v6, v6
    v_mul_f32 v6, 0xba000000, v6
    v_cos_f32 v8, v6
    v_sin_f32 v9, v6
    v_lshlrev_b32 v5, 3, v5
    v_add_u32 v5, 139264, v5
    ds_write_b64 v5, v[8:9]
    v_add_u32 v5, 1024, v0
    v_lshrrev_b32 v6, 7, v5
    v_and_b32 v7, 127, v5
    v_mul_u32_u24 v6, v6, v7
    v_cvt_f32_u32 v6, v6
    v_mul_f32 v6, 0xba000000, v6
    v_cos_f32 v8, v6
    v_sin_f32 v9, v6
    v_lshlrev_b32 v5, 3, v5
    v_add_u32 v5, 139264, v5
    ds_write_b64 v5, v[8:9]
    v_add_u32 v5, 1536, v0
    v_lshrrev_b32 v6, 7, v5
    v_and_b32 v7, 127, v5
    v_mul_u32_u24 v6, v6, v7
    v_cvt_f32_u32 v6, v6
    v_mul_f32 v6, 0xba000000, v6
    v_cos_f32 v8, v6
    v_sin_f32 v9, v6
    v_lshlrev_b32 v5, 3, v5
    v_add_u32 v5, 139264, v5
    ds_write_b64 v5, v[8:9]
    v_cmp_gt_u32 vcc, 128, v0
    s_and_saveexec_b64 s[34:35], vcc
    v_lshrrev_b32 v6, 3, v0
    v_and_b32 v7, 7, v0
    v_mul_u32_u24 v6, v6, v7
    v_cvt_f32_u32 v6, v6
    v_mul_f32 v6, 0xbc000000, v6
    v_cos_f32 v8, v6
    v_sin_f32 v9, v6
    v_lshlrev_b32 v5, 3, v0
    v_add_u32 v5, 155648, v5
    ds_write_b64 v5, v[8:9]
    s_mov_b64 exec, s[34:35]
    s_waitcnt lgkmcnt(0)
    s_cmp_lg_u32 s33, 7
    s_cbranch_scc1 L_b_go_f
    s_load_dwordx2 s[90:91], s[0:1], 72
    s_waitcnt lgkmcnt(0)
    s_mov_b32 s92, s90
    s_mov_b32 s93, s91
    s_mov_b32 s94, 256
    s_mov_b32 s95, 0x00020000
    v_mov_b32 v245, 0
    s_mov_b32 s50, 400000
L_poll_z0_f:
    buffer_load_dword v244, v245, s[92:95], 0 offen sc0 sc1
    s_waitcnt vmcnt(0)
    v_readfirstlane_b32 s51, v244
    s_sub_u32 s50, s50, 1
    s_cmp_eq_u32 s50, 0
    s_cbranch_scc1 L_pollx_z0_f
    s_cmp_ge_u32 s51, 256
    s_cbranch_scc1 L_pollx_z0_f
    s_sleep 2
    s_branch L_poll_z0_f
L_pollx_z0_f:
    v_mov_b32 v252, 0
    v_mov_b32 v253, 0
    v_mov_b32 v254, 0
    v_mov_b32 v255, 0
    v_lshlrev_b32 v248, 7, v2
    s_mov_b32 s50, 400000
L_poll_a_f:
    s_mov_b32 s51, 0
    buffer_load_dword v244, v248, s[56:59], s51 offen sc0 sc1
    s_mov_b32 s51, 8192
    buffer_load_dword v245, v248, s[56:59], s51 offen sc0 sc1
    s_mov_b32 s51, 16384
    buffer_load_dword v246, v248, s[56:59], s51 offen sc0 sc1
    s_mov_b32 s51, 24576
    buffer_load_dword v247, v248, s[56:59], s51 offen sc0 sc1
    s_waitcnt vmcnt(0)
    v_or_b32 v244, v244, v252
    v_or_b32 v245, v245, v253
    v_min_u32 v244, v244, v245
    v_or_b32 v246, v246, v254
    v_min_u32 v244, v244, v246
    v_or_b32 v247, v247, v255
    v_min_u32 v244, v244, v247
    v_cmp_eq_u32 vcc, 0, v244
    s_sub_u32 s50, s50, 1
    s_cmp_eq_u32 s50, 0
    s_cbranch_scc1 L_pollx_a_f
    s_cmp_eq_u64 vcc, 0
    s_cbranch_scc1 L_pollx_a_f
    s_sleep 2
    s_branch L_poll_a_f
L_pollx_a_f:
L_b_go_f:
    s_barrier
    s_add_u32 s31, s29, 0
    buffer_load_dwordx4 v[16:19], v14, s[12:15], s31 offen
    s_add_u32 s31, s29, 296960
    buffer_load_dwordx4 v[20:23], v14, s[12:15], s31 offen
    s_add_u32 s31, s29, 593920
    buffer_load_dwordx4 v[24:27], v14, s[12:15], s31 offen
    s_add_u32 s31, s29, 890880
    buffer_load_dwordx4 v[28:31], v14, s[12:15], s31 offen
    s_add_u32 s31, s29, 1187840
    buffer_load_dwordx4 v[32:35], v14, s[12:15], s31 offen
    s_add_u32 s31, s29, 1484800
    buffer_load_dwordx4 v[36:39], v14, s[12:15], s31 offen
    s_add_u32 s31, s29, 1781760
    buffer_load_dwordx4 v[40:43], v14, s[12:15], s31 offen
    s_add_u32 s31, s29, 2078720
    buffer_load_dwordx4 v[44:47], v14, s[12:15], s31 offen
    s_add_u32 s31, s29, 2375680
    buffer_load_dwordx4 v[48:51], v14, s[12:15], s31 offen
    s_add_u32 s31, s29, 2672640
    buffer_load_dwordx4 v[52:55], v14, s[12:15], s31 offen
    s_add_u32 s31, s29, 2969600
    buffer_load_dwordx4 v[56:59], v14, s[12:15], s31 offen
    s_add_u32 s31, s29, 3266560
    buffer_load_dwordx4 v[60:63], v14, s[12:15], s31 offen
    s_add_u32 s31, s29, 3563520
    buffer_load_dwordx4 v[64:67], v14, s[12:15], s31 offen
    s_add_u32 s31, s29, 3860480
    buffer_load_dwordx4 v[68:71], v14, s[12:15], s31 offen
    s_add_u32 s31, s29, 4157440
    buffer_load_dwordx4 v[72:75], v14, s[12:15], s31 offen
    s_add_u32 s31, s29, 4454400
    buffer_load_dwordx4 v[76:79], v14, s[12:15], s31 offen
    buffer_load_dword v80, v4, s[16:19], s30 offen offset:0
    buffer_load_dword v81, v4, s[16:19], s30 offen offset:1024
    buffer_load_dword v82, v4, s[16:19], s30 offen offset:2048
    buffer_load_dword v83, v4, s[16:19], s30 offen offset:3072
    s_add_u32 s31, s30, 4096
    buffer_load_dword v84, v4, s[16:19], s31 offen offset:0
    s_add_u32 s31, s30, 5120
    buffer_load_dword v85, v4, s[16:19], s31 offen offset:0
    s_add_u32 s31, s30, 6144
    buffer_load_dword v86, v4, s[16:19], s31 offen offset:0
    s_add_u32 s31, s30, 7168
    buffer_load_dword v87, v4, s[16:19], s31 offen offset:0
    buffer_load_dword v88, v4, s[16:19], s30 offen offset:256
    buffer_load_dword v89, v4, s[16:19], s30 offen offset:1280
    buffer_load_dword v90, v4, s[16:19], s30 offen offset:2304
    buffer_load_dword v91, v4, s[16:19], s30 offen offset:3328
    s_add_u32 s31, s30, 4096
    buffer_load_dword v92, v4, s[16:19], s31 offen offset:256
    s_add_u32 s31, s30, 5120
    buffer_load_dword v93, v4, s[16:19], s31 offen offset:256
    s_add_u32 s31, s30, 6144
    buffer_load_dword v94, v4, s[16:19], s31 offen offset:256
    s_add_u32 s31, s30, 7168
    buffer_load_dword v95, v4, s[16:19], s31 offen offset:256
    buffer_load_dword v96, v4, s[16:19], s30 offen offset:512
    buffer_load_dword v97, v4, s[16:19], s30 offen offset:1536
    buffer_load_dword v98, v4, s[16:19], s30 offen offset:2560
    buffer_load_dword v99, v4, s[16:19], s30 offen offset:3584
    s_add_u32 s31, s30, 4096
    buffer_load_dword v100, v4, s[16:19], s31 offen offset:512
    s_add_u32 s31, s30, 5120
    buffer_load_dword v101, v4, s[16:19], s31 offen offset:512
    s_add_u32 s31, s30, 6144
    buffer_load_dword v102, v4, s[16:19], s31 offen offset:512
    s_add_u32 s31, s30, 7168
    buffer_load_dword v103, v4, s[16:19], s31 offen offset:512
    buffer_load_dword v104, v4, s[16:19], s30 offen offset:768
    buffer_load_dword v105, v4, s[16:19], s30 offen offset:1792
    buffer_load_dword v106, v4, s[16:19], s30 offen offset:2816
    buffer_load_dword v107, v4, s[16:19], s30 offen offset:3840
    s_add_u32 s31, s30, 4096
    buffer_load_dword v108, v4, s[16:19], s31 offen offset:768
    s_add_u32 s31, s30, 5120
    buffer_load_dword v109, v4, s[16:19], s31 offen offset:768
    s_add_u32 s31, s30, 6144
    buffer_load_dword v110, v4, s[16:19], s31 offen offset:768
    s_add_u32 s31, s30, 7168
    buffer_load_dword v111, v4, s[16:19], s31 offen offset:768
    s_cmp_ge_u32 s28, 289
    s_cbranch_scc1 L_phB_done
    s_mul_i32 s32, s33, 17408
    v_add_u32 v5, s32, v3
    v_lshrrev_b32 v10, 2, v2
    v_and_b32 v11, 3, v2
    v_mul_u32_u24 v6, 1088, v10
    v_lshlrev_b32 v12, 4, v11
    v_add_u32 v6, v6, v12
    v_add_u32 v6, s32, v6
    v_mul_u32_u24 v7, 4128, v11
    v_lshlrev_b32 v13, 4, v10
    v_add_u32 v7, v7, v13
    v_add_u32 v7, s32, v7
    v_add_u32 v8, 139264, v3
    v_add_u32 v9, 155648, v12
    ds_read_b128 v[116:119], v8 offset:1024
    ds_read_b128 v[120:123], v8 offset:2048
    ds_read_b128 v[124:127], v8 offset:3072
    ds_read_b128 v[128:131], v8 offset:4096
    ds_read_b128 v[132:135], v8 offset:5120
    ds_read_b128 v[136:139], v8 offset:6144
    ds_read_b128 v[140:143], v8 offset:7168
    ds_read_b128 v[144:147], v8 offset:8192
    ds_read_b128 v[148:151], v8 offset:9216
    ds_read_b128 v[152:155], v8 offset:10240
    ds_read_b128 v[156:159], v8 offset:11264
    ds_read_b128 v[160:163], v8 offset:12288
    ds_read_b128 v[164:167], v8 offset:13312
    ds_read_b128 v[168:171], v8 offset:14336
    ds_read_b128 v[172:175], v8 offset:15360
    s_waitcnt vmcnt(32)
    v_add_f32 v176, v16, v48
    v_add_f32 v177, v17, v49
    v_sub_f32 v178, v16, v48
    v_sub_f32 v179, v17, v49
    v_add_f32 v180, v32, v64
    v_add_f32 v181, v33, v65
    v_sub_f32 v182, v32, v64
    v_sub_f32 v183, v33, v65
    v_add_f32 v184, v176, v180
    v_add_f32 v185, v177, v181
    v_sub_f32 v186, v176, v180
    v_sub_f32 v187, v177, v181
    v_add_f32 v188, v178, v183
    v_sub_f32 v189, v179, v182
    v_sub_f32 v190, v178, v183
    v_add_f32 v191, v179, v182
    v_add_f32 v176, v20, v52
    v_add_f32 v177, v21, v53
    v_sub_f32 v178, v20, v52
    v_sub_f32 v179, v21, v53
    v_add_f32 v180, v36, v68
    v_add_f32 v181, v37, v69
    v_sub_f32 v182, v36, v68
    v_sub_f32 v183, v37, v69
    v_add_f32 v192, v176, v180
    v_add_f32 v193, v177, v181
    v_sub_f32 v194, v176, v180
    v_sub_f32 v195, v177, v181
    v_add_f32 v196, v178, v183
    v_sub_f32 v197, v179, v182
    v_sub_f32 v198, v178, v183
    v_add_f32 v199, v179, v182
    v_mul_f32 v176, 0x3f6c835e, v196
    v_fmamk_f32 v177, v197, 0x3ec3ef15, v176
    v_mul_f32 v176, 0xbec3ef15, v196
    v_fmamk_f32 v178, v197, 0x3f6c835e, v176
    v_mul_f32 v176, 0x3f3504f3, v194
    v_fmamk_f32 v179, v195, 0x3f3504f3, v176
    v_mul_f32 v176, 0xbf3504f3, v194
    v_fmamk_f32 v180, v195, 0x3f3504f3, v176
    v_mul_f32 v176, 0x3ec3ef15, v198
    v_fmamk_f32 v181, v199, 0x3f6c835e, v176
    v_mul_f32 v176, 0xbf6c835e, v198
    v_fmamk_f32 v182, v199, 0x3ec3ef15, v176
    v_add_f32 v176, v24, v56
    v_add_f32 v183, v25, v57
    v_sub_f32 v194, v24, v56
    v_sub_f32 v195, v25, v57
    v_add_f32 v196, v40, v72
    v_add_f32 v197, v41, v73
    v_sub_f32 v198, v40, v72
    v_sub_f32 v199, v41, v73
    v_add_f32 v200, v176, v196
    v_add_f32 v201, v183, v197
    v_sub_f32 v202, v176, v196
    v_sub_f32 v203, v183, v197
    v_add_f32 v204, v194, v199
    v_sub_f32 v205, v195, v198
    v_sub_f32 v206, v194, v199
    v_add_f32 v207, v195, v198
    v_mul_f32 v176, 0x3f3504f3, v204
    v_fmamk_f32 v183, v205, 0x3f3504f3, v176
    v_mul_f32 v176, 0xbf3504f3, v204
    v_fmamk_f32 v194, v205, 0x3f3504f3, v176
    v_mul_f32 v176, 0xbf3504f3, v206
    v_fmamk_f32 v195, v207, 0x3f3504f3, v176
    v_mul_f32 v176, 0xbf3504f3, v206
    v_fmamk_f32 v196, v207, 0xbf3504f3, v176
    v_add_f32 v176, v28, v60
    v_add_f32 v197, v29, v61
    v_sub_f32 v198, v28, v60
    v_sub_f32 v199, v29, v61
    v_add_f32 v204, v44, v76
    v_add_f32 v205, v45, v77
    v_sub_f32 v206, v44, v76
    v_sub_f32 v207, v45, v77
    v_add_f32 v208, v176, v204
    v_add_f32 v209, v197, v205
    v_sub_f32 v210, v176, v204
    v_sub_f32 v211, v197, v205
    v_add_f32 v212, v198, v207
    v_sub_f32 v213, v199, v206
    v_sub_f32 v214, v198, v207
    v_add_f32 v215, v199, v206
    v_mul_f32 v176, 0x3ec3ef15, v212
    v_fmamk_f32 v197, v213, 0x3f6c835e, v176
    v_mul_f32 v176, 0xbf6c835e, v212
    v_fmamk_f32 v198, v213, 0x3ec3ef15, v176
    v_mul_f32 v176, 0xbf3504f3, v210
    v_fmamk_f32 v199, v211, 0x3f3504f3, v176
    v_mul_f32 v176, 0xbf3504f3, v210
    v_fmamk_f32 v204, v211, 0xbf3504f3, v176
    v_mul_f32 v176, 0xbf6c835e, v214
    v_fmamk_f32 v205, v215, 0xbec3ef15, v176
    v_mul_f32 v176, 0x3ec3ef15, v214
    v_fmamk_f32 v206, v215, 0xbf6c835e, v176
    v_add_f32 v176, v184, v200
    v_add_f32 v207, v185, v201
    v_sub_f32 v210, v184, v200
    v_sub_f32 v211, v185, v201
    v_add_f32 v212, v192, v208
    v_add_f32 v213, v193, v209
    v_sub_f32 v214, v192, v208
    v_sub_f32 v215, v193, v209
    v_add_f32 v184, v176, v212
    v_add_f32 v185, v207, v213
    v_sub_f32 v192, v176, v212
    v_sub_f32 v193, v207, v213
    v_add_f32 v200, v210, v215
    v_sub_f32 v201, v211, v214
    v_sub_f32 v208, v210, v215
    v_add_f32 v209, v211, v214
    v_add_f32 v176, v188, v183
    v_add_f32 v207, v189, v194
    v_sub_f32 v210, v188, v183
    v_sub_f32 v211, v189, v194
    v_add_f32 v212, v177, v197
    v_add_f32 v213, v178, v198
    v_sub_f32 v214, v177, v197
    v_sub_f32 v215, v178, v198
    v_add_f32 v177, v176, v212
    v_add_f32 v178, v207, v213
    v_sub_f32 v183, v176, v212
    v_sub_f32 v188, v207, v213
    v_add_f32 v189, v210, v215
    v_sub_f32 v194, v211, v214
    v_sub_f32 v197, v210, v215
    v_add_f32 v198, v211, v214
    v_add_f32 v176, v186, v203
    v_sub_f32 v207, v187, v202
    v_sub_f32 v210, v186, v203
    v_add_f32 v211, v187, v202
    v_add_f32 v212, v179, v199
    v_add_f32 v213, v180, v204
    v_sub_f32 v214, v179, v199
    v_sub_f32 v215, v180, v204
    v_add_f32 v179, v176, v212
    v_add_f32 v180, v207, v213
    v_sub_f32 v186, v176, v212
    v_sub_f32 v187, v207, v213
    v_add_f32 v199, v210, v215
    v_sub_f32 v202, v211, v214
    v_sub_f32 v203, v210, v215
    v_add_f32 v204, v211, v214
    v_add_f32 v176, v190, v195
    v_add_f32 v207, v191, v196
    v_sub_f32 v210, v190, v195
    v_sub_f32 v211, v191, v196
    v_add_f32 v212, v181, v205
    v_add_f32 v213, v182, v206
    v_sub_f32 v214, v181, v205
    v_sub_f32 v215, v182, v206
    v_add_f32 v181, v176, v212
    v_add_f32 v182, v207, v213
    v_sub_f32 v190, v176, v212
    v_sub_f32 v191, v207, v213
    v_add_f32 v195, v210, v215
    v_sub_f32 v196, v211, v214
    v_sub_f32 v205, v210, v215
    v_add_f32 v206, v211, v214
    v_add_f32 v176, v18, v50
    v_add_f32 v207, v19, v51
    v_sub_f32 v210, v18, v50
    v_sub_f32 v211, v19, v51
    v_add_f32 v212, v34, v66
    v_add_f32 v213, v35, v67
    v_sub_f32 v214, v34, v66
    v_sub_f32 v215, v35, v67
    v_add_f32 v216, v176, v212
    v_add_f32 v217, v207, v213
    v_sub_f32 v218, v176, v212
    v_sub_f32 v219, v207, v213
    v_add_f32 v220, v210, v215
    v_sub_f32 v221, v211, v214
    v_sub_f32 v222, v210, v215
    v_add_f32 v223, v211, v214
    v_add_f32 v176, v22, v54
    v_add_f32 v207, v23, v55
    v_sub_f32 v210, v22, v54
    v_sub_f32 v211, v23, v55
    v_add_f32 v212, v38, v70
    v_add_f32 v213, v39, v71
    v_sub_f32 v214, v38, v70
    v_sub_f32 v215, v39, v71
    v_add_f32 v224, v176, v212
    v_add_f32 v225, v207, v213
    v_sub_f32 v226, v176, v212
    v_sub_f32 v227, v207, v213
    v_add_f32 v228, v210, v215
    v_sub_f32 v229, v211, v214
    v_sub_f32 v230, v210, v215
    v_add_f32 v231, v211, v214
    v_mul_f32 v176, 0x3f6c835e, v228
    v_fmamk_f32 v207, v229, 0x3ec3ef15, v176
    v_mul_f32 v176, 0xbec3ef15, v228
    v_fmamk_f32 v210, v229, 0x3f6c835e, v176
    v_mul_f32 v176, 0x3f3504f3, v226
    v_fmamk_f32 v211, v227, 0x3f3504f3, v176
    v_mul_f32 v176, 0xbf3504f3, v226
    v_fmamk_f32 v212, v227, 0x3f3504f3, v176
    v_mul_f32 v176, 0x3ec3ef15, v230
    v_fmamk_f32 v213, v231, 0x3f6c835e, v176
    v_mul_f32 v176, 0xbf6c835e, v230
    v_fmamk_f32 v214, v231, 0x3ec3ef15, v176
    v_add_f32 v176, v26, v58
    v_add_f32 v215, v27, v59
    v_sub_f32 v226, v26, v58
    v_sub_f32 v227, v27, v59
    v_add_f32 v228, v42, v74
    v_add_f32 v229, v43, v75
    v_sub_f32 v230, v42, v74
    v_sub_f32 v231, v43, v75
    v_add_f32 v232, v176, v228
    v_add_f32 v233, v215, v229
    v_sub_f32 v234, v176, v228
    v_sub_f32 v235, v215, v229
    v_add_f32 v236, v226, v231
    v_sub_f32 v237, v227, v230
    v_sub_f32 v238, v226, v231
    v_add_f32 v239, v227, v230
    v_mul_f32 v176, 0x3f3504f3, v236
    v_fmamk_f32 v215, v237, 0x3f3504f3, v176
    v_mul_f32 v176, 0xbf3504f3, v236
    v_fmamk_f32 v226, v237, 0x3f3504f3, v176
    v_mul_f32 v176, 0xbf3504f3, v238
    v_fmamk_f32 v227, v239, 0x3f3504f3, v176
    v_mul_f32 v176, 0xbf3504f3, v238
    v_fmamk_f32 v228, v239, 0xbf3504f3, v176
    v_add_f32 v176, v30, v62
    v_add_f32 v229, v31, v63
    v_sub_f32 v230, v30, v62
    v_sub_f32 v231, v31, v63
    v_add_f32 v236, v46, v78
    v_add_f32 v237, v47, v79
    v_sub_f32 v238, v46, v78
    v_sub_f32 v239, v47, v79
    v_add_f32 v240, v176, v236
    v_add_f32 v241, v229, v237
    v_sub_f32 v242, v176, v236
    v_sub_f32 v243, v229, v237
    v_add_f32 v244, v230, v239
    v_sub_f32 v245, v231, v238
    v_sub_f32 v246, v230, v239
    v_add_f32 v247, v231, v238
    v_mul_f32 v176, 0x3ec3ef15, v244
    v_fmamk_f32 v229, v245, 0x3f6c835e, v176
    v_mul_f32 v176, 0xbf6c835e, v244
    v_fmamk_f32 v230, v245, 0x3ec3ef15, v176
    v_mul_f32 v176, 0xbf3504f3, v242
    v_fmamk_f32 v231, v243, 0x3f3504f3, v176
    v_mul_f32 v176, 0xbf3504f3, v242
    v_fmamk_f32 v236, v243, 0xbf3504f3, v176
    v_mul_f32 v176, 0xbf6c835e, v246
    v_fmamk_f32 v237, v247, 0xbec3ef15, v176
    v_mul_f32 v176, 0x3ec3ef15, v246
    v_fmamk_f32 v238, v247, 0xbf6c835e, v176
    v_add_f32 v176, v216, v232
    v_add_f32 v239, v217, v233
    v_sub_f32 v242, v216, v232
    v_sub_f32 v243, v217, v233
    v_add_f32 v244, v224, v240
    v_add_f32 v245, v225, v241
    v_sub_f32 v246, v224, v240
    v_sub_f32 v247, v225, v241
    v_add_f32 v216, v176, v244
    v_add_f32 v217, v239, v245
    v_sub_f32 v224, v176, v244
    v_sub_f32 v225, v239, v245
    v_add_f32 v232, v242, v247
    v_sub_f32 v233, v243, v246
    v_sub_f32 v240, v242, v247
    v_add_f32 v241, v243, v246
    v_add_f32 v176, v220, v215
    v_add_f32 v239, v221, v226
    v_sub_f32 v242, v220, v215
    v_sub_f32 v243, v221, v226
    v_add_f32 v244, v207, v229
    v_add_f32 v245, v210, v230
    v_sub_f32 v246, v207, v229
    v_sub_f32 v247, v210, v230
    v_add_f32 v207, v176, v244
    v_add_f32 v210, v239, v245
    v_sub_f32 v215, v176, v244
    v_sub_f32 v220, v239, v245
    v_add_f32 v221, v242, v247
    v_sub_f32 v226, v243, v246
    v_sub_f32 v229, v242, v247
    v_add_f32 v230, v243, v246
    v_add_f32 v176, v218, v235
    v_sub_f32 v239, v219, v234
    v_sub_f32 v242, v218, v235
    v_add_f32 v243, v219, v234
    v_add_f32 v244, v211, v231
    v_add_f32 v245, v212, v236
    v_sub_f32 v246, v211, v231
    v_sub_f32 v247, v212, v236
    v_add_f32 v211, v176, v244
    v_add_f32 v212, v239, v245
    v_sub_f32 v218, v176, v244
    v_sub_f32 v219, v239, v245
    v_add_f32 v231, v242, v247
    v_sub_f32 v234, v243, v246
    v_sub_f32 v235, v242, v247
    v_add_f32 v236, v243, v246
    v_add_f32 v176, v222, v227
    v_add_f32 v239, v223, v228
    v_sub_f32 v242, v222, v227
    v_sub_f32 v243, v223, v228
    v_add_f32 v244, v213, v237
    v_add_f32 v245, v214, v238
    v_sub_f32 v246, v213, v237
    v_sub_f32 v247, v214, v238
    v_add_f32 v213, v176, v244
    v_add_f32 v214, v239, v245
    v_sub_f32 v222, v176, v244
    v_sub_f32 v223, v239, v245
    v_add_f32 v227, v242, v247
    v_sub_f32 v228, v243, v246
    v_sub_f32 v237, v242, v247
    v_add_f32 v238, v243, v246
    s_waitcnt lgkmcnt(0)
    v_mov_b32 v16, v184
    v_mov_b32 v17, v185
    v_mov_b32 v18, v216
    v_mov_b32 v19, v217
    ds_write_b128 v5, v[16:19] offset:0
    v_mul_f32 v176, v177, v116
    v_fma_f32 v20, -v178, v117, v176
    v_mul_f32 v176, v177, v117
    v_fma_f32 v21, v178, v116, v176
    v_mul_f32 v176, v207, v118
    v_fma_f32 v22, -v210, v119, v176
    v_mul_f32 v176, v207, v119
    v_fma_f32 v23, v210, v118, v176
    ds_write_b128 v5, v[20:23] offset:1088
    v_mul_f32 v176, v179, v120
    v_fma_f32 v24, -v180, v121, v176
    v_mul_f32 v176, v179, v121
    v_fma_f32 v25, v180, v120, v176
    v_mul_f32 v176, v211, v122
    v_fma_f32 v26, -v212, v123, v176
    v_mul_f32 v176, v211, v123
    v_fma_f32 v27, v212, v122, v176
    ds_write_b128 v5, v[24:27] offset:2176
    v_mul_f32 v176, v181, v124
    v_fma_f32 v28, -v182, v125, v176
    v_mul_f32 v176, v181, v125
    v_fma_f32 v29, v182, v124, v176
    v_mul_f32 v176, v213, v126
    v_fma_f32 v30, -v214, v127, v176
    v_mul_f32 v176, v213, v127
    v_fma_f32 v31, v214, v126, v176
    ds_write_b128 v5, v[28:31] offset:3264
    v_mul_f32 v176, v200, v128
    v_fma_f32 v32, -v201, v129, v176
    v_mul_f32 v176, v200, v129
    v_fma_f32 v33, v201, v128, v176
    v_mul_f32 v176, v232, v130
    v_fma_f32 v34, -v233, v131, v176
    v_mul_f32 v176, v232, v131
    v_fma_f32 v35, v233, v130, v176
    ds_write_b128 v5, v[32:35] offset:4352
    v_mul_f32 v176, v189, v132
    v_fma_f32 v36, -v194, v133, v176
    v_mul_f32 v176, v189, v133
    v_fma_f32 v37, v194, v132, v176
    v_mul_f32 v176, v221, v134
    v_fma_f32 v38, -v226, v135, v176
    v_mul_f32 v176, v221, v135
    v_fma_f32 v39, v226, v134, v176
    ds_write_b128 v5, v[36:39] offset:5440
    v_mul_f32 v176, v199, v136
    v_fma_f32 v40, -v202, v137, v176
    v_mul_f32 v176, v199, v137
    v_fma_f32 v41, v202, v136, v176
    v_mul_f32 v176, v231, v138
    v_fma_f32 v42, -v234, v139, v176
    v_mul_f32 v176, v231, v139
    v_fma_f32 v43, v234, v138, v176
    ds_write_b128 v5, v[40:43] offset:6528
    v_mul_f32 v176, v195, v140
    v_fma_f32 v44, -v196, v141, v176
    v_mul_f32 v176, v195, v141
    v_fma_f32 v45, v196, v140, v176
    v_mul_f32 v176, v227, v142
    v_fma_f32 v46, -v228, v143, v176
    v_mul_f32 v176, v227, v143
    v_fma_f32 v47, v228, v142, v176
    ds_write_b128 v5, v[44:47] offset:7616
    v_mul_f32 v176, v192, v144
    v_fma_f32 v48, -v193, v145, v176
    v_mul_f32 v176, v192, v145
    v_fma_f32 v49, v193, v144, v176
    v_mul_f32 v176, v224, v146
    v_fma_f32 v50, -v225, v147, v176
    v_mul_f32 v176, v224, v147
    v_fma_f32 v51, v225, v146, v176
    ds_write_b128 v5, v[48:51] offset:8704
    v_mul_f32 v176, v183, v148
    v_fma_f32 v52, -v188, v149, v176
    v_mul_f32 v176, v183, v149
    v_fma_f32 v53, v188, v148, v176
    v_mul_f32 v176, v215, v150
    v_fma_f32 v54, -v220, v151, v176
    v_mul_f32 v176, v215, v151
    v_fma_f32 v55, v220, v150, v176
    ds_write_b128 v5, v[52:55] offset:9792
    v_mul_f32 v176, v186, v152
    v_fma_f32 v56, -v187, v153, v176
    v_mul_f32 v176, v186, v153
    v_fma_f32 v57, v187, v152, v176
    v_mul_f32 v176, v218, v154
    v_fma_f32 v58, -v219, v155, v176
    v_mul_f32 v176, v218, v155
    v_fma_f32 v59, v219, v154, v176
    ds_write_b128 v5, v[56:59] offset:10880
    v_mul_f32 v176, v190, v156
    v_fma_f32 v60, -v191, v157, v176
    v_mul_f32 v176, v190, v157
    v_fma_f32 v61, v191, v156, v176
    v_mul_f32 v176, v222, v158
    v_fma_f32 v62, -v223, v159, v176
    v_mul_f32 v176, v222, v159
    v_fma_f32 v63, v223, v158, v176
    ds_write_b128 v5, v[60:63] offset:11968
    v_mul_f32 v176, v208, v160
    v_fma_f32 v64, -v209, v161, v176
    v_mul_f32 v176, v208, v161
    v_fma_f32 v65, v209, v160, v176
    v_mul_f32 v176, v240, v162
    v_fma_f32 v66, -v241, v163, v176
    v_mul_f32 v176, v240, v163
    v_fma_f32 v67, v241, v162, v176
    ds_write_b128 v5, v[64:67] offset:13056
    v_mul_f32 v176, v197, v164
    v_fma_f32 v68, -v198, v165, v176
    v_mul_f32 v176, v197, v165
    v_fma_f32 v69, v198, v164, v176
    v_mul_f32 v176, v229, v166
    v_fma_f32 v70, -v230, v167, v176
    v_mul_f32 v176, v229, v167
    v_fma_f32 v71, v230, v166, v176
    ds_write_b128 v5, v[68:71] offset:14144
    v_mul_f32 v176, v203, v168
    v_fma_f32 v72, -v204, v169, v176
    v_mul_f32 v176, v203, v169
    v_fma_f32 v73, v204, v168, v176
    v_mul_f32 v176, v235, v170
    v_fma_f32 v74, -v236, v171, v176
    v_mul_f32 v176, v235, v171
    v_fma_f32 v75, v236, v170, v176
    ds_write_b128 v5, v[72:75] offset:15232
    v_mul_f32 v176, v205, v172
    v_fma_f32 v76, -v206, v173, v176
    v_mul_f32 v176, v205, v173
    v_fma_f32 v77, v206, v172, v176
    v_mul_f32 v176, v237, v174
    v_fma_f32 v78, -v238, v175, v176
    v_mul_f32 v176, v237, v175
    v_fma_f32 v79, v238, v174, v176
    ds_write_b128 v5, v[76:79] offset:16320
    ds_read_b128 v[16:19], v6 offset:0
    ds_read_b128 v[20:23], v6 offset:64
    ds_read_b128 v[24:27], v6 offset:128
    ds_read_b128 v[28:31], v6 offset:192
    ds_read_b128 v[32:35], v6 offset:256
    ds_read_b128 v[36:39], v6 offset:320
    ds_read_b128 v[40:43], v6 offset:384
    ds_read_b128 v[44:47], v6 offset:448
    ds_read_b128 v[48:51], v6 offset:512
    ds_read_b128 v[52:55], v6 offset:576
    ds_read_b128 v[56:59], v6 offset:640
    ds_read_b128 v[60:63], v6 offset:704
    ds_read_b128 v[64:67], v6 offset:768
    ds_read_b128 v[68:71], v6 offset:832
    ds_read_b128 v[72:75], v6 offset:896
    ds_read_b128 v[76:79], v6 offset:960
    ds_read_b128 v[116:119], v9 offset:64
    ds_read_b128 v[120:123], v9 offset:128
    ds_read_b128 v[124:127], v9 offset:192
    ds_read_b128 v[128:131], v9 offset:256
    ds_read_b128 v[132:135], v9 offset:320
    ds_read_b128 v[136:139], v9 offset:384
    ds_read_b128 v[140:143], v9 offset:448
    ds_read_b128 v[144:147], v9 offset:512
    ds_read_b128 v[148:151], v9 offset:576
    ds_read_b128 v[152:155], v9 offset:640
    ds_read_b128 v[156:159], v9 offset:704
    ds_read_b128 v[160:163], v9 offset:768
    ds_read_b128 v[164:167], v9 offset:832
    ds_read_b128 v[168:171], v9 offset:896
    ds_read_b128 v[172:175], v9 offset:960
    s_waitcnt lgkmcnt(15)
    v_add_f32 v176, v16, v48
    v_add_f32 v177, v17, v49
    v_sub_f32 v178, v16, v48
    v_sub_f32 v179, v17, v49
    v_add_f32 v180, v32, v64
    v_add_f32 v181, v33, v65
    v_sub_f32 v182, v32, v64
    v_sub_f32 v183, v33, v65
    v_add_f32 v184, v176, v180
    v_add_f32 v185, v177, v181
    v_sub_f32 v186, v176, v180
    v_sub_f32 v187, v177, v181
    v_add_f32 v188, v178, v183
    v_sub_f32 v189, v179, v182
    v_sub_f32 v190, v178, v183
    v_add_f32 v191, v179, v182
    v_add_f32 v176, v20, v52
    v_add_f32 v177, v21, v53
    v_sub_f32 v178, v20, v52
    v_sub_f32 v179, v21, v53
    v_add_f32 v180, v36, v68
    v_add_f32 v181, v37, v69
    v_sub_f32 v182, v36, v68
    v_sub_f32 v183, v37, v69
    v_add_f32 v192, v176, v180
    v_add_f32 v193, v177, v181
    v_sub_f32 v194, v176, v180
    v_sub_f32 v195, v177, v181
    v_add_f32 v196, v178, v183
    v_sub_f32 v197, v179, v182
    v_sub_f32 v198, v178, v183
    v_add_f32 v199, v179, v182
    v_mul_f32 v176, 0x3f6c835e, v196
    v_fmamk_f32 v177, v197, 0x3ec3ef15, v176
    v_mul_f32 v176, 0xbec3ef15, v196
    v_fmamk_f32 v178, v197, 0x3f6c835e, v176
    v_mul_f32 v176, 0x3f3504f3, v194
    v_fmamk_f32 v179, v195, 0x3f3504f3, v176
    v_mul_f32 v176, 0xbf3504f3, v194
    v_fmamk_f32 v180, v195, 0x3f3504f3, v176
    v_mul_f32 v176, 0x3ec3ef15, v198
    v_fmamk_f32 v181, v199, 0x3f6c835e, v176
    v_mul_f32 v176, 0xbf6c835e, v198
    v_fmamk_f32 v182, v199, 0x3ec3ef15, v176
    v_add_f32 v176, v24, v56
    v_add_f32 v183, v25, v57
    v_sub_f32 v194, v24, v56
    v_sub_f32 v195, v25, v57
    v_add_f32 v196, v40, v72
    v_add_f32 v197, v41, v73
    v_sub_f32 v198, v40, v72
    v_sub_f32 v199, v41, v73
    v_add_f32 v200, v176, v196
    v_add_f32 v201, v183, v197
    v_sub_f32 v202, v176, v196
    v_sub_f32 v203, v183, v197
    v_add_f32 v204, v194, v199
    v_sub_f32 v205, v195, v198
    v_sub_f32 v206, v194, v199
    v_add_f32 v207, v195, v198
    v_mul_f32 v176, 0x3f3504f3, v204
    v_fmamk_f32 v183, v205, 0x3f3504f3, v176
    v_mul_f32 v176, 0xbf3504f3, v204
    v_fmamk_f32 v194, v205, 0x3f3504f3, v176
    v_mul_f32 v176, 0xbf3504f3, v206
    v_fmamk_f32 v195, v207, 0x3f3504f3, v176
    v_mul_f32 v176, 0xbf3504f3, v206
    v_fmamk_f32 v196, v207, 0xbf3504f3, v176
    v_add_f32 v176, v28, v60
    v_add_f32 v197, v29, v61
    v_sub_f32 v198, v28, v60
    v_sub_f32 v199, v29, v61
    v_add_f32 v204, v44, v76
    v_add_f32 v205, v45, v77
    v_sub_f32 v206, v44, v76
    v_sub_f32 v207, v45, v77
    v_add_f32 v208, v176, v204
    v_add_f32 v209, v197, v205
    v_sub_f32 v210, v176, v204
    v_sub_f32 v211, v197, v205
    v_add_f32 v212, v198, v207
    v_sub_f32 v213, v199, v206
    v_sub_f32 v214, v198, v207
    v_add_f32 v215, v199, v206
    v_mul_f32 v176, 0x3ec3ef15, v212
    v_fmamk_f32 v197, v213, 0x3f6c835e, v176
    v_mul_f32 v176, 0xbf6c835e, v212
    v_fmamk_f32 v198, v213, 0x3ec3ef15, v176
    v_mul_f32 v176, 0xbf3504f3, v210
    v_fmamk_f32 v199, v211, 0x3f3504f3, v176
    v_mul_f32 v176, 0xbf3504f3, v210
    v_fmamk_f32 v204, v211, 0xbf3504f3, v176
    v_mul_f32 v176, 0xbf6c835e, v214
    v_fmamk_f32 v205, v215, 0xbec3ef15, v176
    v_mul_f32 v176, 0x3ec3ef15, v214
    v_fmamk_f32 v206, v215, 0xbf6c835e, v176
    v_add_f32 v176, v184, v200
    v_add_f32 v207, v185, v201
    v_sub_f32 v210, v184, v200
    v_sub_f32 v211, v185, v201
    v_add_f32 v212, v192, v208
    v_add_f32 v213, v193, v209
    v_sub_f32 v214, v192, v208
    v_sub_f32 v215, v193, v209
    v_add_f32 v184, v176, v212
    v_add_f32 v185, v207, v213
    v_sub_f32 v192, v176, v212
    v_sub_f32 v193, v207, v213
    v_add_f32 v200, v210, v215
    v_sub_f32 v201, v211, v214
    v_sub_f32 v208, v210, v215
    v_add_f32 v209, v211, v214
    v_add_f32 v176, v188, v183
    v_add_f32 v207, v189, v194
    v_sub_f32 v210, v188, v183
    v_sub_f32 v211, v189, v194
    v_add_f32 v212, v177, v197
    v_add_f32 v213, v178, v198
    v_sub_f32 v214, v177, v197
    v_sub_f32 v215, v178, v198
    v_add_f32 v177, v176, v212
    v_add_f32 v178, v207, v213
    v_sub_f32 v183, v176, v212
    v_sub_f32 v188, v207, v213
    v_add_f32 v189, v210, v215
    v_sub_f32 v194, v211, v214
    v_sub_f32 v197, v210, v215
    v_add_f32 v198, v211, v214
    v_add_f32 v176, v186, v203
    v_sub_f32 v207, v187, v202
    v_sub_f32 v210, v186, v203
    v_add_f32 v211, v187, v202
    v_add_f32 v212, v179, v199
    v_add_f32 v213, v180, v204
    v_sub_f32 v214, v179, v199
    v_sub_f32 v215, v180, v204
    v_add_f32 v179, v176, v212
    v_add_f32 v180, v207, v213
    v_sub_f32 v186, v176, v212
    v_sub_f32 v187, v207, v213
    v_add_f32 v199, v210, v215
    v_sub_f32 v202, v211, v214
    v_sub_f32 v203, v210, v215
    v_add_f32 v204, v211, v214
    v_add_f32 v176, v190, v195
    v_add_f32 v207, v191, v196
    v_sub_f32 v210, v190, v195
    v_sub_f32 v211, v191, v196
    v_add_f32 v212, v181, v205
    v_add_f32 v213, v182, v206
    v_sub_f32 v214, v181, v205
    v_sub_f32 v215, v182, v206
    v_add_f32 v181, v176, v212
    v_add_f32 v182, v207, v213
    v_sub_f32 v190, v176, v212
    v_sub_f32 v191, v207, v213
    v_add_f32 v195, v210, v215
    v_sub_f32 v196, v211, v214
    v_sub_f32 v205, v210, v215
    v_add_f32 v206, v211, v214
    v_add_f32 v176, v18, v50
    v_add_f32 v207, v19, v51
    v_sub_f32 v210, v18, v50
    v_sub_f32 v211, v19, v51
    v_add_f32 v212, v34, v66
    v_add_f32 v213, v35, v67
    v_sub_f32 v214, v34, v66
    v_sub_f32 v215, v35, v67
    v_add_f32 v216, v176, v212
    v_add_f32 v217, v207, v213
    v_sub_f32 v218, v176, v212
    v_sub_f32 v219, v207, v213
    v_add_f32 v220, v210, v215
    v_sub_f32 v221, v211, v214
    v_sub_f32 v222, v210, v215
    v_add_f32 v223, v211, v214
    v_add_f32 v176, v22, v54
    v_add_f32 v207, v23, v55
    v_sub_f32 v210, v22, v54
    v_sub_f32 v211, v23, v55
    v_add_f32 v212, v38, v70
    v_add_f32 v213, v39, v71
    v_sub_f32 v214, v38, v70
    v_sub_f32 v215, v39, v71
    v_add_f32 v224, v176, v212
    v_add_f32 v225, v207, v213
    v_sub_f32 v226, v176, v212
    v_sub_f32 v227, v207, v213
    v_add_f32 v228, v210, v215
    v_sub_f32 v229, v211, v214
    v_sub_f32 v230, v210, v215
    v_add_f32 v231, v211, v214
    v_mul_f32 v176, 0x3f6c835e, v228
    v_fmamk_f32 v207, v229, 0x3ec3ef15, v176
    v_mul_f32 v176, 0xbec3ef15, v228
    v_fmamk_f32 v210, v229, 0x3f6c835e, v176
    v_mul_f32 v176, 0x3f3504f3, v226
    v_fmamk_f32 v211, v227, 0x3f3504f3, v176
    v_mul_f32 v176, 0xbf3504f3, v226
    v_fmamk_f32 v212, v227, 0x3f3504f3, v176
    v_mul_f32 v176, 0x3ec3ef15, v230
    v_fmamk_f32 v213, v231, 0x3f6c835e, v176
    v_mul_f32 v176, 0xbf6c835e, v230
    v_fmamk_f32 v214, v231, 0x3ec3ef15, v176
    v_add_f32 v176, v26, v58
    v_add_f32 v215, v27, v59
    v_sub_f32 v226, v26, v58
    v_sub_f32 v227, v27, v59
    v_add_f32 v228, v42, v74
    v_add_f32 v229, v43, v75
    v_sub_f32 v230, v42, v74
    v_sub_f32 v231, v43, v75
    v_add_f32 v232, v176, v228
    v_add_f32 v233, v215, v229
    v_sub_f32 v234, v176, v228
    v_sub_f32 v235, v215, v229
    v_add_f32 v236, v226, v231
    v_sub_f32 v237, v227, v230
    v_sub_f32 v238, v226, v231
    v_add_f32 v239, v227, v230
    v_mul_f32 v176, 0x3f3504f3, v236
    v_fmamk_f32 v215, v237, 0x3f3504f3, v176
    v_mul_f32 v176, 0xbf3504f3, v236
    v_fmamk_f32 v226, v237, 0x3f3504f3, v176
    v_mul_f32 v176, 0xbf3504f3, v238
    v_fmamk_f32 v227, v239, 0x3f3504f3, v176
    v_mul_f32 v176, 0xbf3504f3, v238
    v_fmamk_f32 v228, v239, 0xbf3504f3, v176
    v_add_f32 v176, v30, v62
    v_add_f32 v229, v31, v63
    v_sub_f32 v230, v30, v62
    v_sub_f32 v231, v31, v63
    v_add_f32 v236, v46, v78
    v_add_f32 v237, v47, v79
    v_sub_f32 v238, v46, v78
    v_sub_f32 v239, v47, v79
    v_add_f32 v240, v176, v236
    v_add_f32 v241, v229, v237
    v_sub_f32 v242, v176, v236
    v_sub_f32 v243, v229, v237
    v_add_f32 v244, v230, v239
    v_sub_f32 v245, v231, v238
    v_sub_f32 v246, v230, v239
    v_add_f32 v247, v231, v238
    v_mul_f32 v176, 0x3ec3ef15, v244
    v_fmamk_f32 v229, v245, 0x3f6c835e, v176
    v_mul_f32 v176, 0xbf6c835e, v244
    v_fmamk_f32 v230, v245, 0x3ec3ef15, v176
    v_mul_f32 v176, 0xbf3504f3, v242
    v_fmamk_f32 v231, v243, 0x3f3504f3, v176
    v_mul_f32 v176, 0xbf3504f3, v242
    v_fmamk_f32 v236, v243, 0xbf3504f3, v176
    v_mul_f32 v176, 0xbf6c835e, v246
    v_fmamk_f32 v237, v247, 0xbec3ef15, v176
    v_mul_f32 v176, 0x3ec3ef15, v246
    v_fmamk_f32 v238, v247, 0xbf6c835e, v176
    v_add_f32 v176, v216, v232
    v_add_f32 v239, v217, v233
    v_sub_f32 v242, v216, v232
    v_sub_f32 v243, v217, v233
    v_add_f32 v244, v224, v240
    v_add_f32 v245, v225, v241
    v_sub_f32 v246, v224, v240
    v_sub_f32 v247, v225, v241
    v_add_f32 v216, v176, v244
    v_add_f32 v217, v239, v245
    v_sub_f32 v224, v176, v244
    v_sub_f32 v225, v239, v245
    v_add_f32 v232, v242, v247
    v_sub_f32 v233, v243, v246
    v_sub_f32 v240, v242, v247
    v_add_f32 v241, v243, v246
    v_add_f32 v176, v220, v215
    v_add_f32 v239, v221, v226
    v_sub_f32 v242, v220, v215
    v_sub_f32 v243, v221, v226
    v_add_f32 v244, v207, v229
    v_add_f32 v245, v210, v230
    v_sub_f32 v246, v207, v229
    v_sub_f32 v247, v210, v230
    v_add_f32 v207, v176, v244
    v_add_f32 v210, v239, v245
    v_sub_f32 v215, v176, v244
    v_sub_f32 v220, v239, v245
    v_add_f32 v221, v242, v247
    v_sub_f32 v226, v243, v246
    v_sub_f32 v229, v242, v247
    v_add_f32 v230, v243, v246
    v_add_f32 v176, v218, v235
    v_sub_f32 v239, v219, v234
    v_sub_f32 v242, v218, v235
    v_add_f32 v243, v219, v234
    v_add_f32 v244, v211, v231
    v_add_f32 v245, v212, v236
    v_sub_f32 v246, v211, v231
    v_sub_f32 v247, v212, v236
    v_add_f32 v211, v176, v244
    v_add_f32 v212, v239, v245
    v_sub_f32 v218, v176, v244
    v_sub_f32 v219, v239, v245
    v_add_f32 v231, v242, v247
    v_sub_f32 v234, v243, v246
    v_sub_f32 v235, v242, v247
    v_add_f32 v236, v243, v246
    v_add_f32 v176, v222, v227
    v_add_f32 v239, v223, v228
    v_sub_f32 v242, v222, v227
    v_sub_f32 v243, v223, v228
    v_add_f32 v244, v213, v237
    v_add_f32 v245, v214, v238
    v_sub_f32 v246, v213, v237
    v_sub_f32 v247, v214, v238
    v_add_f32 v213, v176, v244
    v_add_f32 v214, v239, v245
    v_sub_f32 v222, v176, v244
    v_sub_f32 v223, v239, v245
    v_add_f32 v227, v242, v247
    v_sub_f32 v228, v243, v246
    v_sub_f32 v237, v242, v247
    v_add_f32 v238, v243, v246
    s_waitcnt lgkmcnt(0)
    v_mov_b32 v16, v184
    v_mov_b32 v17, v185
    v_mov_b32 v18, v216
    v_mov_b32 v19, v217
    ds_write_b128 v7, v[16:19] offset:0
    v_mul_f32 v176, v177, v116
    v_fma_f32 v20, -v178, v117, v176
    v_mul_f32 v176, v177, v117
    v_fma_f32 v21, v178, v116, v176
    v_mul_f32 v176, v207, v118
    v_fma_f32 v22, -v210, v119, v176
    v_mul_f32 v176, v207, v119
    v_fma_f32 v23, v210, v118, v176
    ds_write_b128 v7, v[20:23] offset:256
    v_mul_f32 v176, v179, v120
    v_fma_f32 v24, -v180, v121, v176
    v_mul_f32 v176, v179, v121
    v_fma_f32 v25, v180, v120, v176
    v_mul_f32 v176, v211, v122
    v_fma_f32 v26, -v212, v123, v176
    v_mul_f32 v176, v211, v123
    v_fma_f32 v27, v212, v122, v176
    ds_write_b128 v7, v[24:27] offset:512
    v_mul_f32 v176, v181, v124
    v_fma_f32 v28, -v182, v125, v176
    v_mul_f32 v176, v181, v125
    v_fma_f32 v29, v182, v124, v176
    v_mul_f32 v176, v213, v126
    v_fma_f32 v30, -v214, v127, v176
    v_mul_f32 v176, v213, v127
    v_fma_f32 v31, v214, v126, v176
    ds_write_b128 v7, v[28:31] offset:768
    v_mul_f32 v176, v200, v128
    v_fma_f32 v32, -v201, v129, v176
    v_mul_f32 v176, v200, v129
    v_fma_f32 v33, v201, v128, v176
    v_mul_f32 v176, v232, v130
    v_fma_f32 v34, -v233, v131, v176
    v_mul_f32 v176, v232, v131
    v_fma_f32 v35, v233, v130, v176
    ds_write_b128 v7, v[32:35] offset:1024
    v_mul_f32 v176, v189, v132
    v_fma_f32 v36, -v194, v133, v176
    v_mul_f32 v176, v189, v133
    v_fma_f32 v37, v194, v132, v176
    v_mul_f32 v176, v221, v134
    v_fma_f32 v38, -v226, v135, v176
    v_mul_f32 v176, v221, v135
    v_fma_f32 v39, v226, v134, v176
    ds_write_b128 v7, v[36:39] offset:1280
    v_mul_f32 v176, v199, v136
    v_fma_f32 v40, -v202, v137, v176
    v_mul_f32 v176, v199, v137
    v_fma_f32 v41, v202, v136, v176
    v_mul_f32 v176, v231, v138
    v_fma_f32 v42, -v234, v139, v176
    v_mul_f32 v176, v231, v139
    v_fma_f32 v43, v234, v138, v176
    ds_write_b128 v7, v[40:43] offset:1536
    v_mul_f32 v176, v195, v140
    v_fma_f32 v44, -v196, v141, v176
    v_mul_f32 v176, v195, v141
    v_fma_f32 v45, v196, v140, v176
    v_mul_f32 v176, v227, v142
    v_fma_f32 v46, -v228, v143, v176
    v_mul_f32 v176, v227, v143
    v_fma_f32 v47, v228, v142, v176
    ds_write_b128 v7, v[44:47] offset:1792
    v_mul_f32 v176, v192, v144
    v_fma_f32 v48, -v193, v145, v176
    v_mul_f32 v176, v192, v145
    v_fma_f32 v49, v193, v144, v176
    v_mul_f32 v176, v224, v146
    v_fma_f32 v50, -v225, v147, v176
    v_mul_f32 v176, v224, v147
    v_fma_f32 v51, v225, v146, v176
    ds_write_b128 v7, v[48:51] offset:2048
    v_mul_f32 v176, v183, v148
    v_fma_f32 v52, -v188, v149, v176
    v_mul_f32 v176, v183, v149
    v_fma_f32 v53, v188, v148, v176
    v_mul_f32 v176, v215, v150
    v_fma_f32 v54, -v220, v151, v176
    v_mul_f32 v176, v215, v151
    v_fma_f32 v55, v220, v150, v176
    ds_write_b128 v7, v[52:55] offset:2304
    v_mul_f32 v176, v186, v152
    v_fma_f32 v56, -v187, v153, v176
    v_mul_f32 v176, v186, v153
    v_fma_f32 v57, v187, v152, v176
    v_mul_f32 v176, v218, v154
    v_fma_f32 v58, -v219, v155, v176
    v_mul_f32 v176, v218, v155
    v_fma_f32 v59, v219, v154, v176
    ds_write_b128 v7, v[56:59] offset:2560
    v_mul_f32 v176, v190, v156
    v_fma_f32 v60, -v191, v157, v176
    v_mul_f32 v176, v190, v157
    v_fma_f32 v61, v191, v156, v176
    v_mul_f32 v176, v222, v158
    v_fma_f32 v62, -v223, v159, v176
    v_mul_f32 v176, v222, v159
    v_fma_f32 v63, v223, v158, v176
    ds_write_b128 v7, v[60:63] offset:2816
    v_mul_f32 v176, v208, v160
    v_fma_f32 v64, -v209, v161, v176
    v_mul_f32 v176, v208, v161
    v_fma_f32 v65, v209, v160, v176
    v_mul_f32 v176, v240, v162
    v_fma_f32 v66, -v241, v163, v176
    v_mul_f32 v176, v240, v163
    v_fma_f32 v67, v241, v162, v176
    ds_write_b128 v7, v[64:67] offset:3072
    v_mul_f32 v176, v197, v164
    v_fma_f32 v68, -v198, v165, v176
    v_mul_f32 v176, v197, v165
    v_fma_f32 v69, v198, v164, v176
    v_mul_f32 v176, v229, v166
    v_fma_f32 v70, -v230, v167, v176
    v_mul_f32 v176, v229, v167
    v_fma_f32 v71, v230, v166, v176
    ds_write_b128 v7, v[68:71] offset:3328
    v_mul_f32 v176, v203, v168
    v_fma_f32 v72, -v204, v169, v176
    v_mul_f32 v176, v203, v169
    v_fma_f32 v73, v204, v168, v176
    v_mul_f32 v176, v235, v170
    v_fma_f32 v74, -v236, v171, v176
    v_mul_f32 v176, v235, v171
    v_fma_f32 v75, v236, v170, v176
    ds_write_b128 v7, v[72:75] offset:3584
    v_mul_f32 v176, v205, v172
    v_fma_f32 v76, -v206, v173, v176
    v_mul_f32 v176, v205, v173
    v_fma_f32 v77, v206, v172, v176
    v_mul_f32 v176, v237, v174
    v_fma_f32 v78, -v238, v175, v176
    v_mul_f32 v176, v237, v175
    v_fma_f32 v79, v238, v174, v176
    ds_write_b128 v7, v[76:79] offset:3840
    ds_read_b128 v[16:19], v5 offset:0
    ds_read_b128 v[20:23], v5 offset:4128
    ds_read_b128 v[24:27], v5 offset:8256
    ds_read_b128 v[28:31], v5 offset:12384
    ds_read_b128 v[32:35], v5 offset:1024
    ds_read_b128 v[36:39], v5 offset:5152
    ds_read_b128 v[40:43], v5 offset:9280
    ds_read_b128 v[44:47], v5 offset:13408
    ds_read_b128 v[48:51], v5 offset:2048
    ds_read_b128 v[52:55], v5 offset:6176
    ds_read_b128 v[56:59], v5 offset:10304
    ds_read_b128 v[60:63], v5 offset:14432
    ds_read_b128 v[64:67], v5 offset:3072
    ds_read_b128 v[68:71], v5 offset:7200
    ds_read_b128 v[72:75], v5 offset:11328
    ds_read_b128 v[76:79], v5 offset:15456
    s_waitcnt vmcnt(0) lgkmcnt(0)
    v_add_f32 v176, v16, v24
    v_add_f32 v177, v17, v25
    v_sub_f32 v178, v16, v24
    v_sub_f32 v179, v17, v25
    v_add_f32 v180, v18, v26
    v_add_f32 v181, v19, v27
    v_sub_f32 v182, v18, v26
    v_sub_f32 v183, v19, v27
    v_mul_f32 v184, 0x3f3504f3, v182
    v_fmamk_f32 v185, v183, 0x3f3504f3, v184
    v_mul_f32 v184, 0xbf3504f3, v182
    v_fmamk_f32 v186, v183, 0x3f3504f3, v184
    v_add_f32 v182, v20, v28
    v_add_f32 v183, v21, v29
    v_sub_f32 v184, v20, v28
    v_sub_f32 v187, v21, v29
    v_add_f32 v188, v22, v30
    v_add_f32 v189, v23, v31
    v_sub_f32 v190, v22, v30
    v_sub_f32 v191, v23, v31
    v_mul_f32 v192, 0xbf3504f3, v190
    v_fmamk_f32 v193, v191, 0x3f3504f3, v192
    v_mul_f32 v192, 0xbf3504f3, v190
    v_fmamk_f32 v194, v191, 0xbf3504f3, v192
    v_add_f32 v190, v176, v182
    v_add_f32 v191, v177, v183
    v_sub_f32 v192, v176, v182
    v_sub_f32 v195, v177, v183
    v_add_f32 v196, v180, v188
    v_add_f32 v197, v181, v189
    v_sub_f32 v198, v180, v188
    v_sub_f32 v199, v181, v189
    v_add_f32 v176, v190, v196
    v_add_f32 v177, v191, v197
    v_sub_f32 v180, v190, v196
    v_sub_f32 v181, v191, v197
    v_add_f32 v182, v192, v199
    v_sub_f32 v183, v195, v198
    v_sub_f32 v188, v192, v199
    v_add_f32 v189, v195, v198
    v_add_f32 v190, v178, v187
    v_sub_f32 v191, v179, v184
    v_sub_f32 v192, v178, v187
    v_add_f32 v195, v179, v184
    v_add_f32 v196, v185, v193
    v_add_f32 v197, v186, v194
    v_sub_f32 v198, v185, v193
    v_sub_f32 v199, v186, v194
    v_add_f32 v178, v190, v196
    v_add_f32 v179, v191, v197
    v_sub_f32 v184, v190, v196
    v_sub_f32 v185, v191, v197
    v_add_f32 v186, v192, v199
    v_sub_f32 v187, v195, v198
    v_sub_f32 v193, v192, v199
    v_add_f32 v194, v195, v198
    v_lshlrev_b32 v190, 16, v80
    v_and_b32 v191, 0xffff0000, v80
    v_mul_f32 v192, v176, v190
    v_fma_f32 v195, -v177, v191, v192
    v_mul_f32 v192, v176, v191
    v_fma_f32 v196, v177, v190, v192
    v_lshlrev_b32 v176, 16, v81
    v_and_b32 v177, 0xffff0000, v81
    v_mul_f32 v190, v178, v176
    v_fma_f32 v191, -v179, v177, v190
    v_mul_f32 v190, v178, v177
    v_fma_f32 v192, v179, v176, v190
    v_lshlrev_b32 v176, 16, v82
    v_and_b32 v177, 0xffff0000, v82
    v_mul_f32 v178, v182, v176
    v_fma_f32 v179, -v183, v177, v178
    v_mul_f32 v178, v182, v177
    v_fma_f32 v190, v183, v176, v178
    v_lshlrev_b32 v176, 16, v83
    v_and_b32 v177, 0xffff0000, v83
    v_mul_f32 v178, v186, v176
    v_fma_f32 v182, -v187, v177, v178
    v_mul_f32 v178, v186, v177
    v_fma_f32 v183, v187, v176, v178
    v_lshlrev_b32 v176, 16, v84
    v_and_b32 v177, 0xffff0000, v84
    v_mul_f32 v178, v180, v176
    v_fma_f32 v186, -v181, v177, v178
    v_mul_f32 v178, v180, v177
    v_fma_f32 v187, v181, v176, v178
    v_lshlrev_b32 v176, 16, v85
    v_and_b32 v177, 0xffff0000, v85
    v_mul_f32 v178, v184, v176
    v_fma_f32 v180, -v185, v177, v178
    v_mul_f32 v178, v184, v177
    v_fma_f32 v181, v185, v176, v178
    v_lshlrev_b32 v176, 16, v86
    v_and_b32 v177, 0xffff0000, v86
    v_mul_f32 v178, v188, v176
    v_fma_f32 v184, -v189, v177, v178
    v_mul_f32 v178, v188, v177
    v_fma_f32 v185, v189, v176, v178
    v_lshlrev_b32 v176, 16, v87
    v_and_b32 v177, 0xffff0000, v87
    v_mul_f32 v178, v193, v176
    v_fma_f32 v188, -v194, v177, v178
    v_mul_f32 v178, v193, v177
    v_fma_f32 v189, v194, v176, v178
    v_add_f32 v176, v195, v186
    v_add_f32 v177, v196, v187
    v_sub_f32 v178, v195, v186
    v_sub_f32 v193, v196, v187
    v_add_f32 v186, v191, v180
    v_add_f32 v187, v192, v181
    v_sub_f32 v194, v191, v180
    v_sub_f32 v195, v192, v181
    v_mul_f32 v180, 0x3f3504f3, v194
    v_fmamk_f32 v181, v195, 0xbf3504f3, v180
    v_mul_f32 v180, 0x3f3504f3, v194
    v_fmamk_f32 v191, v195, 0x3f3504f3, v180
    v_add_f32 v180, v179, v184
    v_add_f32 v192, v190, v185
    v_sub_f32 v194, v179, v184
    v_sub_f32 v195, v190, v185
    v_add_f32 v179, v182, v188
    v_add_f32 v184, v183, v189
    v_sub_f32 v185, v182, v188
    v_sub_f32 v190, v183, v189
    v_mul_f32 v182, 0xbf3504f3, v185
    v_fmamk_f32 v183, v190, 0xbf3504f3, v182
    v_mul_f32 v182, 0x3f3504f3, v185
    v_fmamk_f32 v188, v190, 0xbf3504f3, v182
    v_add_f32 v182, v176, v180
    v_add_f32 v185, v177, v192
    v_sub_f32 v189, v176, v180
    v_sub_f32 v190, v177, v192
    v_add_f32 v196, v186, v179
    v_add_f32 v197, v187, v184
    v_sub_f32 v198, v186, v179
    v_sub_f32 v199, v187, v184
    v_add_f32 v16, v182, v196
    v_add_f32 v17, v185, v197
    v_sub_f32 v24, v182, v196
    v_sub_f32 v25, v185, v197
    v_sub_f32 v20, v189, v199
    v_add_f32 v21, v190, v198
    v_add_f32 v28, v189, v199
    v_sub_f32 v29, v190, v198
    v_sub_f32 v176, v178, v195
    v_add_f32 v177, v193, v194
    v_add_f32 v179, v178, v195
    v_sub_f32 v180, v193, v194
    v_add_f32 v182, v181, v183
    v_add_f32 v184, v191, v188
    v_sub_f32 v185, v181, v183
    v_sub_f32 v186, v191, v188
    v_add_f32 v18, v176, v182
    v_add_f32 v19, v177, v184
    v_sub_f32 v26, v176, v182
    v_sub_f32 v27, v177, v184
    v_sub_f32 v22, v179, v186
    v_add_f32 v23, v180, v185
    v_add_f32 v30, v179, v186
    v_sub_f32 v31, v180, v185
    ds_write_b128 v5, v[16:19] offset:0
    ds_write_b128 v5, v[20:23] offset:4128
    ds_write_b128 v5, v[24:27] offset:8256
    ds_write_b128 v5, v[28:31] offset:12384
    v_add_f32 v176, v32, v40
    v_add_f32 v177, v33, v41
    v_sub_f32 v178, v32, v40
    v_sub_f32 v179, v33, v41
    v_add_f32 v180, v34, v42
    v_add_f32 v181, v35, v43
    v_sub_f32 v182, v34, v42
    v_sub_f32 v183, v35, v43
    v_mul_f32 v184, 0x3f3504f3, v182
    v_fmamk_f32 v185, v183, 0x3f3504f3, v184
    v_mul_f32 v184, 0xbf3504f3, v182
    v_fmamk_f32 v186, v183, 0x3f3504f3, v184
    v_add_f32 v182, v36, v44
    v_add_f32 v183, v37, v45
    v_sub_f32 v184, v36, v44
    v_sub_f32 v187, v37, v45
    v_add_f32 v188, v38, v46
    v_add_f32 v189, v39, v47
    v_sub_f32 v190, v38, v46
    v_sub_f32 v191, v39, v47
    v_mul_f32 v192, 0xbf3504f3, v190
    v_fmamk_f32 v193, v191, 0x3f3504f3, v192
    v_mul_f32 v192, 0xbf3504f3, v190
    v_fmamk_f32 v194, v191, 0xbf3504f3, v192
    v_add_f32 v190, v176, v182
    v_add_f32 v191, v177, v183
    v_sub_f32 v192, v176, v182
    v_sub_f32 v195, v177, v183
    v_add_f32 v196, v180, v188
    v_add_f32 v197, v181, v189
    v_sub_f32 v198, v180, v188
    v_sub_f32 v199, v181, v189
    v_add_f32 v176, v190, v196
    v_add_f32 v177, v191, v197
    v_sub_f32 v180, v190, v196
    v_sub_f32 v181, v191, v197
    v_add_f32 v182, v192, v199
    v_sub_f32 v183, v195, v198
    v_sub_f32 v188, v192, v199
    v_add_f32 v189, v195, v198
    v_add_f32 v190, v178, v187
    v_sub_f32 v191, v179, v184
    v_sub_f32 v192, v178, v187
    v_add_f32 v195, v179, v184
    v_add_f32 v196, v185, v193
    v_add_f32 v197, v186, v194
    v_sub_f32 v198, v185, v193
    v_sub_f32 v199, v186, v194
    v_add_f32 v178, v190, v196
    v_add_f32 v179, v191, v197
    v_sub_f32 v184, v190, v196
    v_sub_f32 v185, v191, v197
    v_add_f32 v186, v192, v199
    v_sub_f32 v187, v195, v198
    v_sub_f32 v193, v192, v199
    v_add_f32 v194, v195, v198
    v_lshlrev_b32 v190, 16, v88
    v_and_b32 v191, 0xffff0000, v88
    v_mul_f32 v192, v176, v190
    v_fma_f32 v195, -v177, v191, v192
    v_mul_f32 v192, v176, v191
    v_fma_f32 v196, v177, v190, v192
    v_lshlrev_b32 v176, 16, v89
    v_and_b32 v177, 0xffff0000, v89
    v_mul_f32 v190, v178, v176
    v_fma_f32 v191, -v179, v177, v190
    v_mul_f32 v190, v178, v177
    v_fma_f32 v192, v179, v176, v190
    v_lshlrev_b32 v176, 16, v90
    v_and_b32 v177, 0xffff0000, v90
    v_mul_f32 v178, v182, v176
    v_fma_f32 v179, -v183, v177, v178
    v_mul_f32 v178, v182, v177
    v_fma_f32 v190, v183, v176, v178
    v_lshlrev_b32 v176, 16, v91
    v_and_b32 v177, 0xffff0000, v91
    v_mul_f32 v178, v186, v176
    v_fma_f32 v182, -v187, v177, v178
    v_mul_f32 v178, v186, v177
    v_fma_f32 v183, v187, v176, v178
    v_lshlrev_b32 v176, 16, v92
    v_and_b32 v177, 0xffff0000, v92
    v_mul_f32 v178, v180, v176
    v_fma_f32 v186, -v181, v177, v178
    v_mul_f32 v178, v180, v177
    v_fma_f32 v187, v181, v176, v178
    v_lshlrev_b32 v176, 16, v93
    v_and_b32 v177, 0xffff0000, v93
    v_mul_f32 v178, v184, v176
    v_fma_f32 v180, -v185, v177, v178
    v_mul_f32 v178, v184, v177
    v_fma_f32 v181, v185, v176, v178
    v_lshlrev_b32 v176, 16, v94
    v_and_b32 v177, 0xffff0000, v94
    v_mul_f32 v178, v188, v176
    v_fma_f32 v184, -v189, v177, v178
    v_mul_f32 v178, v188, v177
    v_fma_f32 v185, v189, v176, v178
    v_lshlrev_b32 v176, 16, v95
    v_and_b32 v177, 0xffff0000, v95
    v_mul_f32 v178, v193, v176
    v_fma_f32 v188, -v194, v177, v178
    v_mul_f32 v178, v193, v177
    v_fma_f32 v189, v194, v176, v178
    v_add_f32 v176, v195, v186
    v_add_f32 v177, v196, v187
    v_sub_f32 v178, v195, v186
    v_sub_f32 v193, v196, v187
    v_add_f32 v186, v191, v180
    v_add_f32 v187, v192, v181
    v_sub_f32 v194, v191, v180
    v_sub_f32 v195, v192, v181
    v_mul_f32 v180, 0x3f3504f3, v194
    v_fmamk_f32 v181, v195, 0xbf3504f3, v180
    v_mul_f32 v180, 0x3f3504f3, v194
    v_fmamk_f32 v191, v195, 0x3f3504f3, v180
    v_add_f32 v180, v179, v184
    v_add_f32 v192, v190, v185
    v_sub_f32 v194, v179, v184
    v_sub_f32 v195, v190, v185
    v_add_f32 v179, v182, v188
    v_add_f32 v184, v183, v189
    v_sub_f32 v185, v182, v188
    v_sub_f32 v190, v183, v189
    v_mul_f32 v182, 0xbf3504f3, v185
    v_fmamk_f32 v183, v190, 0xbf3504f3, v182
    v_mul_f32 v182, 0x3f3504f3, v185
    v_fmamk_f32 v188, v190, 0xbf3504f3, v182
    v_add_f32 v182, v176, v180
    v_add_f32 v185, v177, v192
    v_sub_f32 v189, v176, v180
    v_sub_f32 v190, v177, v192
    v_add_f32 v196, v186, v179
    v_add_f32 v197, v187, v184
    v_sub_f32 v198, v186, v179
    v_sub_f32 v199, v187, v184
    v_add_f32 v32, v182, v196
    v_add_f32 v33, v185, v197
    v_sub_f32 v40, v182, v196
    v_sub_f32 v41, v185, v197
    v_sub_f32 v36, v189, v199
    v_add_f32 v37, v190, v198
    v_add_f32 v44, v189, v199
    v_sub_f32 v45, v190, v198
    v_sub_f32 v176, v178, v195
    v_add_f32 v177, v193, v194
    v_add_f32 v179, v178, v195
    v_sub_f32 v180, v193, v194
    v_add_f32 v182, v181, v183
    v_add_f32 v184, v191, v188
    v_sub_f32 v185, v181, v183
    v_sub_f32 v186, v191, v188
    v_add_f32 v34, v176, v182
    v_add_f32 v35, v177, v184
    v_sub_f32 v42, v176, v182
    v_sub_f32 v43, v177, v184
    v_sub_f32 v38, v179, v186
    v_add_f32 v39, v180, v185
    v_add_f32 v46, v179, v186
    v_sub_f32 v47, v180, v185
    ds_write_b128 v5, v[32:35] offset:1024
    ds_write_b128 v5, v[36:39] offset:5152
    ds_write_b128 v5, v[40:43] offset:9280
    ds_write_b128 v5, v[44:47] offset:13408
    v_add_f32 v176, v48, v56
    v_add_f32 v177, v49, v57
    v_sub_f32 v178, v48, v56
    v_sub_f32 v179, v49, v57
    v_add_f32 v180, v50, v58
    v_add_f32 v181, v51, v59
    v_sub_f32 v182, v50, v58
    v_sub_f32 v183, v51, v59
    v_mul_f32 v184, 0x3f3504f3, v182
    v_fmamk_f32 v185, v183, 0x3f3504f3, v184
    v_mul_f32 v184, 0xbf3504f3, v182
    v_fmamk_f32 v186, v183, 0x3f3504f3, v184
    v_add_f32 v182, v52, v60
    v_add_f32 v183, v53, v61
    v_sub_f32 v184, v52, v60
    v_sub_f32 v187, v53, v61
    v_add_f32 v188, v54, v62
    v_add_f32 v189, v55, v63
    v_sub_f32 v190, v54, v62
    v_sub_f32 v191, v55, v63
    v_mul_f32 v192, 0xbf3504f3, v190
    v_fmamk_f32 v193, v191, 0x3f3504f3, v192
    v_mul_f32 v192, 0xbf3504f3, v190
    v_fmamk_f32 v194, v191, 0xbf3504f3, v192
    v_add_f32 v190, v176, v182
    v_add_f32 v191, v177, v183
    v_sub_f32 v192, v176, v182
    v_sub_f32 v195, v177, v183
    v_add_f32 v196, v180, v188
    v_add_f32 v197, v181, v189
    v_sub_f32 v198, v180, v188
    v_sub_f32 v199, v181, v189
    v_add_f32 v176, v190, v196
    v_add_f32 v177, v191, v197
    v_sub_f32 v180, v190, v196
    v_sub_f32 v181, v191, v197
    v_add_f32 v182, v192, v199
    v_sub_f32 v183, v195, v198
    v_sub_f32 v188, v192, v199
    v_add_f32 v189, v195, v198
    v_add_f32 v190, v178, v187
    v_sub_f32 v191, v179, v184
    v_sub_f32 v192, v178, v187
    v_add_f32 v195, v179, v184
    v_add_f32 v196, v185, v193
    v_add_f32 v197, v186, v194
    v_sub_f32 v198, v185, v193
    v_sub_f32 v199, v186, v194
    v_add_f32 v178, v190, v196
    v_add_f32 v179, v191, v197
    v_sub_f32 v184, v190, v196
    v_sub_f32 v185, v191, v197
    v_add_f32 v186, v192, v199
    v_sub_f32 v187, v195, v198
    v_sub_f32 v193, v192, v199
    v_add_f32 v194, v195, v198
    v_lshlrev_b32 v190, 16, v96
    v_and_b32 v191, 0xffff0000, v96
    v_mul_f32 v192, v176, v190
    v_fma_f32 v195, -v177, v191, v192
    v_mul_f32 v192, v176, v191
    v_fma_f32 v196, v177, v190, v192
    v_lshlrev_b32 v176, 16, v97
    v_and_b32 v177, 0xffff0000, v97
    v_mul_f32 v190, v178, v176
    v_fma_f32 v191, -v179, v177, v190
    v_mul_f32 v190, v178, v177
    v_fma_f32 v192, v179, v176, v190
    v_lshlrev_b32 v176, 16, v98
    v_and_b32 v177, 0xffff0000, v98
    v_mul_f32 v178, v182, v176
    v_fma_f32 v179, -v183, v177, v178
    v_mul_f32 v178, v182, v177
    v_fma_f32 v190, v183, v176, v178
    v_lshlrev_b32 v176, 16, v99
    v_and_b32 v177, 0xffff0000, v99
    v_mul_f32 v178, v186, v176
    v_fma_f32 v182, -v187, v177, v178
    v_mul_f32 v178, v186, v177
    v_fma_f32 v183, v187, v176, v178
    v_lshlrev_b32 v176, 16, v100
    v_and_b32 v177, 0xffff0000, v100
    v_mul_f32 v178, v180, v176
    v_fma_f32 v186, -v181, v177, v178
    v_mul_f32 v178, v180, v177
    v_fma_f32 v187, v181, v176, v178
    v_lshlrev_b32 v176, 16, v101
    v_and_b32 v177, 0xffff0000, v101
    v_mul_f32 v178, v184, v176
    v_fma_f32 v180, -v185, v177, v178
    v_mul_f32 v178, v184, v177
    v_fma_f32 v181, v185, v176, v178
    v_lshlrev_b32 v176, 16, v102
    v_and_b32 v177, 0xffff0000, v102
    v_mul_f32 v178, v188, v176
    v_fma_f32 v184, -v189, v177, v178
    v_mul_f32 v178, v188, v177
    v_fma_f32 v185, v189, v176, v178
    v_lshlrev_b32 v176, 16, v103
    v_and_b32 v177, 0xffff0000, v103
    v_mul_f32 v178, v193, v176
    v_fma_f32 v188, -v194, v177, v178
    v_mul_f32 v178, v193, v177
    v_fma_f32 v189, v194, v176, v178
    v_add_f32 v176, v195, v186
    v_add_f32 v177, v196, v187
    v_sub_f32 v178, v195, v186
    v_sub_f32 v193, v196, v187
    v_add_f32 v186, v191, v180
    v_add_f32 v187, v192, v181
    v_sub_f32 v194, v191, v180
    v_sub_f32 v195, v192, v181
    v_mul_f32 v180, 0x3f3504f3, v194
    v_fmamk_f32 v181, v195, 0xbf3504f3, v180
    v_mul_f32 v180, 0x3f3504f3, v194
    v_fmamk_f32 v191, v195, 0x3f3504f3, v180
    v_add_f32 v180, v179, v184
    v_add_f32 v192, v190, v185
    v_sub_f32 v194, v179, v184
    v_sub_f32 v195, v190, v185
    v_add_f32 v179, v182, v188
    v_add_f32 v184, v183, v189
    v_sub_f32 v185, v182, v188
    v_sub_f32 v190, v183, v189
    v_mul_f32 v182, 0xbf3504f3, v185
    v_fmamk_f32 v183, v190, 0xbf3504f3, v182
    v_mul_f32 v182, 0x3f3504f3, v185
    v_fmamk_f32 v188, v190, 0xbf3504f3, v182
    v_add_f32 v182, v176, v180
    v_add_f32 v185, v177, v192
    v_sub_f32 v189, v176, v180
    v_sub_f32 v190, v177, v192
    v_add_f32 v196, v186, v179
    v_add_f32 v197, v187, v184
    v_sub_f32 v198, v186, v179
    v_sub_f32 v199, v187, v184
    v_add_f32 v48, v182, v196
    v_add_f32 v49, v185, v197
    v_sub_f32 v56, v182, v196
    v_sub_f32 v57, v185, v197
    v_sub_f32 v52, v189, v199
    v_add_f32 v53, v190, v198
    v_add_f32 v60, v189, v199
    v_sub_f32 v61, v190, v198
    v_sub_f32 v176, v178, v195
    v_add_f32 v177, v193, v194
    v_add_f32 v179, v178, v195
    v_sub_f32 v180, v193, v194
    v_add_f32 v182, v181, v183
    v_add_f32 v184, v191, v188
    v_sub_f32 v185, v181, v183
    v_sub_f32 v186, v191, v188
    v_add_f32 v50, v176, v182
    v_add_f32 v51, v177, v184
    v_sub_f32 v58, v176, v182
    v_sub_f32 v59, v177, v184
    v_sub_f32 v54, v179, v186
    v_add_f32 v55, v180, v185
    v_add_f32 v62, v179, v186
    v_sub_f32 v63, v180, v185
    ds_write_b128 v5, v[48:51] offset:2048
    ds_write_b128 v5, v[52:55] offset:6176
    ds_write_b128 v5, v[56:59] offset:10304
    ds_write_b128 v5, v[60:63] offset:14432
    v_add_f32 v176, v64, v72
    v_add_f32 v177, v65, v73
    v_sub_f32 v178, v64, v72
    v_sub_f32 v179, v65, v73
    v_add_f32 v180, v66, v74
    v_add_f32 v181, v67, v75
    v_sub_f32 v182, v66, v74
    v_sub_f32 v183, v67, v75
    v_mul_f32 v184, 0x3f3504f3, v182
    v_fmamk_f32 v185, v183, 0x3f3504f3, v184
    v_mul_f32 v184, 0xbf3504f3, v182
    v_fmamk_f32 v186, v183, 0x3f3504f3, v184
    v_add_f32 v182, v68, v76
    v_add_f32 v183, v69, v77
    v_sub_f32 v184, v68, v76
    v_sub_f32 v187, v69, v77
    v_add_f32 v188, v70, v78
    v_add_f32 v189, v71, v79
    v_sub_f32 v190, v70, v78
    v_sub_f32 v191, v71, v79
    v_mul_f32 v192, 0xbf3504f3, v190
    v_fmamk_f32 v193, v191, 0x3f3504f3, v192
    v_mul_f32 v192, 0xbf3504f3, v190
    v_fmamk_f32 v194, v191, 0xbf3504f3, v192
    v_add_f32 v190, v176, v182
    v_add_f32 v191, v177, v183
    v_sub_f32 v192, v176, v182
    v_sub_f32 v195, v177, v183
    v_add_f32 v196, v180, v188
    v_add_f32 v197, v181, v189
    v_sub_f32 v198, v180, v188
    v_sub_f32 v199, v181, v189
    v_add_f32 v176, v190, v196
    v_add_f32 v177, v191, v197
    v_sub_f32 v180, v190, v196
    v_sub_f32 v181, v191, v197
    v_add_f32 v182, v192, v199
    v_sub_f32 v183, v195, v198
    v_sub_f32 v188, v192, v199
    v_add_f32 v189, v195, v198
    v_add_f32 v190, v178, v187
    v_sub_f32 v191, v179, v184
    v_sub_f32 v192, v178, v187
    v_add_f32 v195, v179, v184
    v_add_f32 v196, v185, v193
    v_add_f32 v197, v186, v194
    v_sub_f32 v198, v185, v193
    v_sub_f32 v199, v186, v194
    v_add_f32 v178, v190, v196
    v_add_f32 v179, v191, v197
    v_sub_f32 v184, v190, v196
    v_sub_f32 v185, v191, v197
    v_add_f32 v186, v192, v199
    v_sub_f32 v187, v195, v198
    v_sub_f32 v193, v192, v199
    v_add_f32 v194, v195, v198
    v_lshlrev_b32 v190, 16, v104
    v_and_b32 v191, 0xffff0000, v104
    v_mul_f32 v192, v176, v190
    v_fma_f32 v195, -v177, v191, v192
    v_mul_f32 v192, v176, v191
    v_fma_f32 v196, v177, v190, v192
    v_lshlrev_b32 v176, 16, v105
    v_and_b32 v177, 0xffff0000, v105
    v_mul_f32 v190, v178, v176
    v_fma_f32 v191, -v179, v177, v190
    v_mul_f32 v190, v178, v177
    v_fma_f32 v192, v179, v176, v190
    v_lshlrev_b32 v176, 16, v106
    v_and_b32 v177, 0xffff0000, v106
    v_mul_f32 v178, v182, v176
    v_fma_f32 v179, -v183, v177, v178
    v_mul_f32 v178, v182, v177
    v_fma_f32 v190, v183, v176, v178
    v_lshlrev_b32 v176, 16, v107
    v_and_b32 v177, 0xffff0000, v107
    v_mul_f32 v178, v186, v176
    v_fma_f32 v182, -v187, v177, v178
    v_mul_f32 v178, v186, v177
    v_fma_f32 v183, v187, v176, v178
    v_lshlrev_b32 v176, 16, v108
    v_and_b32 v177, 0xffff0000, v108
    v_mul_f32 v178, v180, v176
    v_fma_f32 v186, -v181, v177, v178
    v_mul_f32 v178, v180, v177
    v_fma_f32 v187, v181, v176, v178
    v_lshlrev_b32 v176, 16, v109
    v_and_b32 v177, 0xffff0000, v109
    v_mul_f32 v178, v184, v176
    v_fma_f32 v180, -v185, v177, v178
    v_mul_f32 v178, v184, v177
    v_fma_f32 v181, v185, v176, v178
    v_lshlrev_b32 v176, 16, v110
    v_and_b32 v177, 0xffff0000, v110
    v_mul_f32 v178, v188, v176
    v_fma_f32 v184, -v189, v177, v178
    v_mul_f32 v178, v188, v177
    v_fma_f32 v185, v189, v176, v178
    v_lshlrev_b32 v176, 16, v111
    v_and_b32 v177, 0xffff0000, v111
    v_mul_f32 v178, v193, v176
    v_fma_f32 v188, -v194, v177, v178
    v_mul_f32 v178, v193, v177
    v_fma_f32 v189, v194, v176, v178
    v_add_f32 v176, v195, v186
    v_add_f32 v177, v196, v187
    v_sub_f32 v178, v195, v186
    v_sub_f32 v193, v196, v187
    v_add_f32 v186, v191, v180
    v_add_f32 v187, v192, v181
    v_sub_f32 v194, v191, v180
    v_sub_f32 v195, v192, v181
    v_mul_f32 v180, 0x3f3504f3, v194
    v_fmamk_f32 v181, v195, 0xbf3504f3, v180
    v_mul_f32 v180, 0x3f3504f3, v194
    v_fmamk_f32 v191, v195, 0x3f3504f3, v180
    v_add_f32 v180, v179, v184
    v_add_f32 v192, v190, v185
    v_sub_f32 v194, v179, v184
    v_sub_f32 v195, v190, v185
    v_add_f32 v179, v182, v188
    v_add_f32 v184, v183, v189
    v_sub_f32 v185, v182, v188
    v_sub_f32 v190, v183, v189
    v_mul_f32 v182, 0xbf3504f3, v185
    v_fmamk_f32 v183, v190, 0xbf3504f3, v182
    v_mul_f32 v182, 0x3f3504f3, v185
    v_fmamk_f32 v188, v190, 0xbf3504f3, v182
    v_add_f32 v182, v176, v180
    v_add_f32 v185, v177, v192
    v_sub_f32 v189, v176, v180
    v_sub_f32 v190, v177, v192
    v_add_f32 v196, v186, v179
    v_add_f32 v197, v187, v184
    v_sub_f32 v198, v186, v179
    v_sub_f32 v199, v187, v184
    v_add_f32 v64, v182, v196
    v_add_f32 v65, v185, v197
    v_sub_f32 v72, v182, v196
    v_sub_f32 v73, v185, v197
    v_sub_f32 v68, v189, v199
    v_add_f32 v69, v190, v198
    v_add_f32 v76, v189, v199
    v_sub_f32 v77, v190, v198
    v_sub_f32 v176, v178, v195
    v_add_f32 v177, v193, v194
    v_add_f32 v179, v178, v195
    v_sub_f32 v180, v193, v194
    v_add_f32 v182, v181, v183
    v_add_f32 v184, v191, v188
    v_sub_f32 v185, v181, v183
    v_sub_f32 v186, v191, v188
    v_add_f32 v66, v176, v182
    v_add_f32 v67, v177, v184
    v_sub_f32 v74, v176, v182
    v_sub_f32 v75, v177, v184
    v_sub_f32 v70, v179, v186
    v_add_f32 v71, v180, v185
    v_add_f32 v78, v179, v186
    v_sub_f32 v79, v180, v185
    ds_write_b128 v5, v[64:67] offset:3072
    ds_write_b128 v5, v[68:71] offset:7200
    ds_write_b128 v5, v[72:75] offset:11328
    ds_write_b128 v5, v[76:79] offset:15456
    ds_read_b128 v[16:19], v7 offset:0
    ds_read_b128 v[20:23], v7 offset:256
    ds_read_b128 v[24:27], v7 offset:512
    ds_read_b128 v[28:31], v7 offset:768
    ds_read_b128 v[32:35], v7 offset:1024
    ds_read_b128 v[36:39], v7 offset:1280
    ds_read_b128 v[40:43], v7 offset:1536
    ds_read_b128 v[44:47], v7 offset:1792
    ds_read_b128 v[48:51], v7 offset:2048
    ds_read_b128 v[52:55], v7 offset:2304
    ds_read_b128 v[56:59], v7 offset:2560
    ds_read_b128 v[60:63], v7 offset:2816
    ds_read_b128 v[64:67], v7 offset:3072
    ds_read_b128 v[68:71], v7 offset:3328
    ds_read_b128 v[72:75], v7 offset:3584
    ds_read_b128 v[76:79], v7 offset:3840
    s_waitcnt lgkmcnt(0)
    v_mul_f32 v176, v20, v116
    v_fma_f32 v177, v21, v117, v176
    v_mul_f32 v176, v20, v117
    v_fma_f32 v178, v21, v116, -v176
    v_mul_f32 v176, v22, v118
    v_fma_f32 v179, v23, v119, v176
    v_mul_f32 v176, v22, v119
    v_fma_f32 v180, v23, v118, -v176
    v_mul_f32 v176, v24, v120
    v_fma_f32 v181, v25, v121, v176
    v_mul_f32 v176, v24, v121
    v_fma_f32 v182, v25, v120, -v176
    v_mul_f32 v176, v26, v122
    v_fma_f32 v183, v27, v123, v176
    v_mul_f32 v176, v26, v123
    v_fma_f32 v184, v27, v122, -v176
    v_mul_f32 v176, v28, v124
    v_fma_f32 v185, v29, v125, v176
    v_mul_f32 v176, v28, v125
    v_fma_f32 v186, v29, v124, -v176
    v_mul_f32 v176, v30, v126
    v_fma_f32 v187, v31, v127, v176
    v_mul_f32 v176, v30, v127
    v_fma_f32 v188, v31, v126, -v176
    v_mul_f32 v176, v32, v128
    v_fma_f32 v189, v33, v129, v176
    v_mul_f32 v176, v32, v129
    v_fma_f32 v190, v33, v128, -v176
    v_mul_f32 v176, v34, v130
    v_fma_f32 v191, v35, v131, v176
    v_mul_f32 v176, v34, v131
    v_fma_f32 v192, v35, v130, -v176
    v_mul_f32 v176, v36, v132
    v_fma_f32 v193, v37, v133, v176
    v_mul_f32 v176, v36, v133
    v_fma_f32 v194, v37, v132, -v176
    v_mul_f32 v176, v38, v134
    v_fma_f32 v195, v39, v135, v176
    v_mul_f32 v176, v38, v135
    v_fma_f32 v196, v39, v134, -v176
    v_mul_f32 v176, v40, v136
    v_fma_f32 v197, v41, v137, v176
    v_mul_f32 v176, v40, v137
    v_fma_f32 v198, v41, v136, -v176
    v_mul_f32 v176, v42, v138
    v_fma_f32 v199, v43, v139, v176
    v_mul_f32 v176, v42, v139
    v_fma_f32 v200, v43, v138, -v176
    v_mul_f32 v176, v44, v140
    v_fma_f32 v201, v45, v141, v176
    v_mul_f32 v176, v44, v141
    v_fma_f32 v202, v45, v140, -v176
    v_mul_f32 v176, v46, v142
    v_fma_f32 v203, v47, v143, v176
    v_mul_f32 v176, v46, v143
    v_fma_f32 v204, v47, v142, -v176
    v_mul_f32 v176, v48, v144
    v_fma_f32 v205, v49, v145, v176
    v_mul_f32 v176, v48, v145
    v_fma_f32 v206, v49, v144, -v176
    v_mul_f32 v176, v50, v146
    v_fma_f32 v207, v51, v147, v176
    v_mul_f32 v176, v50, v147
    v_fma_f32 v208, v51, v146, -v176
    v_mul_f32 v176, v52, v148
    v_fma_f32 v209, v53, v149, v176
    v_mul_f32 v176, v52, v149
    v_fma_f32 v210, v53, v148, -v176
    v_mul_f32 v176, v54, v150
    v_fma_f32 v211, v55, v151, v176
    v_mul_f32 v176, v54, v151
    v_fma_f32 v212, v55, v150, -v176
    v_mul_f32 v176, v56, v152
    v_fma_f32 v213, v57, v153, v176
    v_mul_f32 v176, v56, v153
    v_fma_f32 v214, v57, v152, -v176
    v_mul_f32 v176, v58, v154
    v_fma_f32 v215, v59, v155, v176
    v_mul_f32 v176, v58, v155
    v_fma_f32 v216, v59, v154, -v176
    v_mul_f32 v176, v60, v156
    v_fma_f32 v217, v61, v157, v176
    v_mul_f32 v176, v60, v157
    v_fma_f32 v218, v61, v156, -v176
    v_mul_f32 v176, v62, v158
    v_fma_f32 v219, v63, v159, v176
    v_mul_f32 v176, v62, v159
    v_fma_f32 v220, v63, v158, -v176
    v_mul_f32 v176, v64, v160
    v_fma_f32 v221, v65, v161, v176
    v_mul_f32 v176, v64, v161
    v_fma_f32 v222, v65, v160, -v176
    v_mul_f32 v176, v66, v162
    v_fma_f32 v223, v67, v163, v176
    v_mul_f32 v176, v66, v163
    v_fma_f32 v224, v67, v162, -v176
    v_mul_f32 v176, v68, v164
    v_fma_f32 v225, v69, v165, v176
    v_mul_f32 v176, v68, v165
    v_fma_f32 v226, v69, v164, -v176
    v_mul_f32 v176, v70, v166
    v_fma_f32 v227, v71, v167, v176
    v_mul_f32 v176, v70, v167
    v_fma_f32 v228, v71, v166, -v176
    v_mul_f32 v176, v72, v168
    v_fma_f32 v229, v73, v169, v176
    v_mul_f32 v176, v72, v169
    v_fma_f32 v230, v73, v168, -v176
    v_mul_f32 v176, v74, v170
    v_fma_f32 v231, v75, v171, v176
    v_mul_f32 v176, v74, v171
    v_fma_f32 v232, v75, v170, -v176
    v_mul_f32 v176, v76, v172
    v_fma_f32 v233, v77, v173, v176
    v_mul_f32 v176, v76, v173
    v_fma_f32 v234, v77, v172, -v176
    v_mul_f32 v176, v78, v174
    v_fma_f32 v235, v79, v175, v176
    v_mul_f32 v176, v78, v175
    v_fma_f32 v236, v79, v174, -v176
    ds_read_b128 v[116:119], v8 offset:1024
    ds_read_b128 v[120:123], v8 offset:2048
    ds_read_b128 v[124:127], v8 offset:3072
    ds_read_b128 v[128:131], v8 offset:4096
    ds_read_b128 v[132:135], v8 offset:5120
    ds_read_b128 v[136:139], v8 offset:6144
    ds_read_b128 v[140:143], v8 offset:7168
    ds_read_b128 v[144:147], v8 offset:8192
    ds_read_b128 v[148:151], v8 offset:9216
    ds_read_b128 v[152:155], v8 offset:10240
    ds_read_b128 v[156:159], v8 offset:11264
    ds_read_b128 v[160:163], v8 offset:12288
    ds_read_b128 v[164:167], v8 offset:13312
    ds_read_b128 v[168:171], v8 offset:14336
    ds_read_b128 v[172:175], v8 offset:15360
    v_add_f32 v176, v16, v205
    v_add_f32 v237, v17, v206
    v_sub_f32 v238, v16, v205
    v_sub_f32 v239, v17, v206
    v_add_f32 v240, v189, v221
    v_add_f32 v241, v190, v222
    v_sub_f32 v242, v189, v221
    v_sub_f32 v243, v190, v222
    v_add_f32 v189, v176, v240
    v_add_f32 v190, v237, v241
    v_sub_f32 v205, v176, v240
    v_sub_f32 v206, v237, v241
    v_sub_f32 v221, v238, v243
    v_add_f32 v222, v239, v242
    v_add_f32 v244, v238, v243
    v_sub_f32 v245, v239, v242
    v_add_f32 v176, v177, v209
    v_add_f32 v237, v178, v210
    v_sub_f32 v238, v177, v209
    v_sub_f32 v239, v178, v210
    v_add_f32 v240, v193, v225
    v_add_f32 v241, v194, v226
    v_sub_f32 v242, v193, v225
    v_sub_f32 v243, v194, v226
    v_add_f32 v177, v176, v240
    v_add_f32 v178, v237, v241
    v_sub_f32 v193, v176, v240
    v_sub_f32 v194, v237, v241
    v_sub_f32 v209, v238, v243
    v_add_f32 v210, v239, v242
    v_add_f32 v225, v238, v243
    v_sub_f32 v226, v239, v242
    v_mul_f32 v176, 0x3f6c835e, v209
    v_fmamk_f32 v237, v210, 0xbec3ef15, v176
    v_mul_f32 v176, 0x3ec3ef15, v209
    v_fmamk_f32 v238, v210, 0x3f6c835e, v176
    v_mul_f32 v176, 0x3f3504f3, v193
    v_fmamk_f32 v209, v194, 0xbf3504f3, v176
    v_mul_f32 v176, 0x3f3504f3, v193
    v_fmamk_f32 v210, v194, 0x3f3504f3, v176
    v_mul_f32 v176, 0x3ec3ef15, v225
    v_fmamk_f32 v193, v226, 0xbf6c835e, v176
    v_mul_f32 v176, 0x3f6c835e, v225
    v_fmamk_f32 v194, v226, 0x3ec3ef15, v176
    v_add_f32 v176, v181, v213
    v_add_f32 v225, v182, v214
    v_sub_f32 v226, v181, v213
    v_sub_f32 v239, v182, v214
    v_add_f32 v240, v197, v229
    v_add_f32 v241, v198, v230
    v_sub_f32 v242, v197, v229
    v_sub_f32 v243, v198, v230
    v_add_f32 v181, v176, v240
    v_add_f32 v182, v225, v241
    v_sub_f32 v197, v176, v240
    v_sub_f32 v198, v225, v241
    v_sub_f32 v213, v226, v243
    v_add_f32 v214, v239, v242
    v_add_f32 v229, v226, v243
    v_sub_f32 v230, v239, v242
    v_mul_f32 v176, 0x3f3504f3, v213
    v_fmamk_f32 v225, v214, 0xbf3504f3, v176
    v_mul_f32 v176, 0x3f3504f3, v213
    v_fmamk_f32 v226, v214, 0x3f3504f3, v176
    v_mul_f32 v176, 0xbf3504f3, v229
    v_fmamk_f32 v213, v230, 0xbf3504f3, v176
    v_mul_f32 v176, 0x3f3504f3, v229
    v_fmamk_f32 v214, v230, 0xbf3504f3, v176
    v_add_f32 v176, v185, v217
    v_add_f32 v229, v186, v218
    v_sub_f32 v230, v185, v217
    v_sub_f32 v239, v186, v218
    v_add_f32 v240, v201, v233
    v_add_f32 v241, v202, v234
    v_sub_f32 v242, v201, v233
    v_sub_f32 v243, v202, v234
    v_add_f32 v185, v176, v240
    v_add_f32 v186, v229, v241
    v_sub_f32 v201, v176, v240
    v_sub_f32 v202, v229, v241
    v_sub_f32 v217, v230, v243
    v_add_f32 v218, v239, v242
    v_add_f32 v233, v230, v243
    v_sub_f32 v234, v239, v242
    v_mul_f32 v176, 0x3ec3ef15, v217
    v_fmamk_f32 v229, v218, 0xbf6c835e, v176
    v_mul_f32 v176, 0x3f6c835e, v217
    v_fmamk_f32 v230, v218, 0x3ec3ef15, v176
    v_mul_f32 v176, 0xbf3504f3, v201
    v_fmamk_f32 v217, v202, 0xbf3504f3, v176
    v_mul_f32 v176, 0x3f3504f3, v201
    v_fmamk_f32 v218, v202, 0xbf3504f3, v176
    v_mul_f32 v176, 0xbf6c835e, v233
    v_fmamk_f32 v201, v234, 0x3ec3ef15, v176
    v_mul_f32 v176, 0xbec3ef15, v233
    v_fmamk_f32 v202, v234, 0xbf6c835e, v176
    v_add_f32 v176, v189, v181
    v_add_f32 v233, v190, v182
    v_sub_f32 v234, v189, v181
    v_sub_f32 v239, v190, v182
    v_add_f32 v240, v177, v185
    v_add_f32 v241, v178, v186
    v_sub_f32 v242, v177, v185
    v_sub_f32 v243, v178, v186
    v_add_f32 v16, v176, v240
    v_add_f32 v17, v233, v241
    v_sub_f32 v48, v176, v240
    v_sub_f32 v49, v233, v241
    v_sub_f32 v32, v234, v243
    v_add_f32 v33, v239, v242
    v_add_f32 v64, v234, v243
    v_sub_f32 v65, v239, v242
    v_add_f32 v176, v221, v225
    v_add_f32 v177, v222, v226
    v_sub_f32 v178, v221, v225
    v_sub_f32 v181, v222, v226
    v_add_f32 v182, v237, v229
    v_add_f32 v185, v238, v230
    v_sub_f32 v186, v237, v229
    v_sub_f32 v189, v238, v230
    v_add_f32 v20, v176, v182
    v_add_f32 v21, v177, v185
    v_sub_f32 v52, v176, v182
    v_sub_f32 v53, v177, v185
    v_sub_f32 v36, v178, v189
    v_add_f32 v37, v181, v186
    v_add_f32 v68, v178, v189
    v_sub_f32 v69, v181, v186
    v_sub_f32 v176, v205, v198
    v_add_f32 v177, v206, v197
    v_add_f32 v178, v205, v198
    v_sub_f32 v181, v206, v197
    v_add_f32 v182, v209, v217
    v_add_f32 v185, v210, v218
    v_sub_f32 v186, v209, v217
    v_sub_f32 v189, v210, v218
    v_add_f32 v24, v176, v182
    v_add_f32 v25, v177, v185
    v_sub_f32 v56, v176, v182
    v_sub_f32 v57, v177, v185
    v_sub_f32 v40, v178, v189
    v_add_f32 v41, v181, v186
    v_add_f32 v72, v178, v189
    v_sub_f32 v73, v181, v186
    v_add_f32 v176, v244, v213
    v_add_f32 v177, v245, v214
    v_sub_f32 v178, v244, v213
    v_sub_f32 v181, v245, v214
    v_add_f32 v182, v193, v201
    v_add_f32 v185, v194, v202
    v_sub_f32 v186, v193, v201
    v_sub_f32 v189, v194, v202
    v_add_f32 v28, v176, v182
    v_add_f32 v29, v177, v185
    v_sub_f32 v60, v176, v182
    v_sub_f32 v61, v177, v185
    v_sub_f32 v44, v178, v189
    v_add_f32 v45, v181, v186
    v_add_f32 v76, v178, v189
    v_sub_f32 v77, v181, v186
    v_add_f32 v176, v18, v207
    v_add_f32 v177, v19, v208
    v_sub_f32 v178, v18, v207
    v_sub_f32 v181, v19, v208
    v_add_f32 v182, v191, v223
    v_add_f32 v185, v192, v224
    v_sub_f32 v186, v191, v223
    v_sub_f32 v189, v192, v224
    v_add_f32 v190, v176, v182
    v_add_f32 v191, v177, v185
    v_sub_f32 v192, v176, v182
    v_sub_f32 v193, v177, v185
    v_sub_f32 v194, v178, v189
    v_add_f32 v197, v181, v186
    v_add_f32 v198, v178, v189
    v_sub_f32 v201, v181, v186
    v_add_f32 v176, v179, v211
    v_add_f32 v177, v180, v212
    v_sub_f32 v178, v179, v211
    v_sub_f32 v181, v180, v212
    v_add_f32 v182, v195, v227
    v_add_f32 v185, v196, v228
    v_sub_f32 v186, v195, v227
    v_sub_f32 v189, v196, v228
    v_add_f32 v179, v176, v182
    v_add_f32 v180, v177, v185
    v_sub_f32 v195, v176, v182
    v_sub_f32 v196, v177, v185
    v_sub_f32 v202, v178, v189
    v_add_f32 v205, v181, v186
    v_add_f32 v206, v178, v189
    v_sub_f32 v207, v181, v186
    v_mul_f32 v176, 0x3f6c835e, v202
    v_fmamk_f32 v177, v205, 0xbec3ef15, v176
    v_mul_f32 v176, 0x3ec3ef15, v202
    v_fmamk_f32 v178, v205, 0x3f6c835e, v176
    v_mul_f32 v176, 0x3f3504f3, v195
    v_fmamk_f32 v181, v196, 0xbf3504f3, v176
    v_mul_f32 v176, 0x3f3504f3, v195
    v_fmamk_f32 v182, v196, 0x3f3504f3, v176
    v_mul_f32 v176, 0x3ec3ef15, v206
    v_fmamk_f32 v185, v207, 0xbf6c835e, v176
    v_mul_f32 v176, 0x3f6c835e, v206
    v_fmamk_f32 v186, v207, 0x3ec3ef15, v176
    v_add_f32 v176, v183, v215
    v_add_f32 v189, v184, v216
    v_sub_f32 v195, v183, v215
    v_sub_f32 v196, v184, v216
    v_add_f32 v202, v199, v231
    v_add_f32 v205, v200, v232
    v_sub_f32 v206, v199, v231
    v_sub_f32 v207, v200, v232
    v_add_f32 v183, v176, v202
    v_add_f32 v184, v189, v205
    v_sub_f32 v199, v176, v202
    v_sub_f32 v200, v189, v205
    v_sub_f32 v208, v195, v207
    v_add_f32 v209, v196, v206
    v_add_f32 v210, v195, v207
    v_sub_f32 v211, v196, v206
    v_mul_f32 v176, 0x3f3504f3, v208
    v_fmamk_f32 v189, v209, 0xbf3504f3, v176
    v_mul_f32 v176, 0x3f3504f3, v208
    v_fmamk_f32 v195, v209, 0x3f3504f3, v176
    v_mul_f32 v176, 0xbf3504f3, v210
    v_fmamk_f32 v196, v211, 0xbf3504f3, v176
    v_mul_f32 v176, 0x3f3504f3, v210
    v_fmamk_f32 v202, v211, 0xbf3504f3, v176
    v_add_f32 v176, v187, v219
    v_add_f32 v205, v188, v220
    v_sub_f32 v206, v187, v219
    v_sub_f32 v207, v188, v220
    v_add_f32 v208, v203, v235
    v_add_f32 v209, v204, v236
    v_sub_f32 v210, v203, v235
    v_sub_f32 v211, v204, v236
    v_add_f32 v187, v176, v208
    v_add_f32 v188, v205, v209
    v_sub_f32 v203, v176, v208
    v_sub_f32 v204, v205, v209
    v_sub_f32 v212, v206, v211
    v_add_f32 v213, v207, v210
    v_add_f32 v214, v206, v211
    v_sub_f32 v215, v207, v210
    v_mul_f32 v176, 0x3ec3ef15, v212
    v_fmamk_f32 v205, v213, 0xbf6c835e, v176
    v_mul_f32 v176, 0x3f6c835e, v212
    v_fmamk_f32 v206, v213, 0x3ec3ef15, v176
    v_mul_f32 v176, 0xbf3504f3, v203
    v_fmamk_f32 v207, v204, 0xbf3504f3, v176
    v_mul_f32 v176, 0x3f3504f3, v203
    v_fmamk_f32 v208, v204, 0xbf3504f3, v176
    v_mul_f32 v176, 0xbf6c835e, v214
    v_fmamk_f32 v203, v215, 0x3ec3ef15, v176
    v_mul_f32 v176, 0xbec3ef15, v214
    v_fmamk_f32 v204, v215, 0xbf6c835e, v176
    v_add_f32 v176, v190, v183
    v_add_f32 v209, v191, v184
    v_sub_f32 v210, v190, v183
    v_sub_f32 v211, v191, v184
    v_add_f32 v212, v179, v187
    v_add_f32 v213, v180, v188
    v_sub_f32 v214, v179, v187
    v_sub_f32 v215, v180, v188
    v_add_f32 v18, v176, v212
    v_add_f32 v19, v209, v213
    v_sub_f32 v50, v176, v212
    v_sub_f32 v51, v209, v213
    v_sub_f32 v34, v210, v215
    v_add_f32 v35, v211, v214
    v_add_f32 v66, v210, v215
    v_sub_f32 v67, v211, v214
    v_add_f32 v176, v194, v189
    v_add_f32 v179, v197, v195
    v_sub_f32 v180, v194, v189
    v_sub_f32 v183, v197, v195
    v_add_f32 v184, v177, v205
    v_add_f32 v187, v178, v206
    v_sub_f32 v188, v177, v205
    v_sub_f32 v190, v178, v206
    v_add_f32 v22, v176, v184
    v_add_f32 v23, v179, v187
    v_sub_f32 v54, v176, v184
    v_sub_f32 v55, v179, v187
    v_sub_f32 v38, v180, v190
    v_add_f32 v39, v183, v188
    v_add_f32 v70, v180, v190
    v_sub_f32 v71, v183, v188
    v_sub_f32 v176, v192, v200
    v_add_f32 v177, v193, v199
    v_add_f32 v178, v192, v200
    v_sub_f32 v179, v193, v199
    v_add_f32 v180, v181, v207
    v_add_f32 v183, v182, v208
    v_sub_f32 v184, v181, v207
    v_sub_f32 v187, v182, v208
    v_add_f32 v26, v176, v180
    v_add_f32 v27, v177, v183
    v_sub_f32 v58, v176, v180
    v_sub_f32 v59, v177, v183
    v_sub_f32 v42, v178, v187
    v_add_f32 v43, v179, v184
    v_add_f32 v74, v178, v187
    v_sub_f32 v75, v179, v184
    v_add_f32 v176, v198, v196
    v_add_f32 v177, v201, v202
    v_sub_f32 v178, v198, v196
    v_sub_f32 v179, v201, v202
    v_add_f32 v180, v185, v203
    v_add_f32 v181, v186, v204
    v_sub_f32 v182, v185, v203
    v_sub_f32 v183, v186, v204
    v_add_f32 v30, v176, v180
    v_add_f32 v31, v177, v181
    v_sub_f32 v62, v176, v180
    v_sub_f32 v63, v177, v181
    v_sub_f32 v46, v178, v183
    v_add_f32 v47, v179, v182
    v_add_f32 v78, v178, v183
    v_sub_f32 v79, v179, v182
    ds_write_b128 v6, v[16:19] offset:0
    ds_write_b128 v6, v[20:23] offset:64
    ds_write_b128 v6, v[24:27] offset:128
    ds_write_b128 v6, v[28:31] offset:192
    ds_write_b128 v6, v[32:35] offset:256
    ds_write_b128 v6, v[36:39] offset:320
    ds_write_b128 v6, v[40:43] offset:384
    ds_write_b128 v6, v[44:47] offset:448
    ds_write_b128 v6, v[48:51] offset:512
    ds_write_b128 v6, v[52:55] offset:576
    ds_write_b128 v6, v[56:59] offset:640
    ds_write_b128 v6, v[60:63] offset:704
    ds_write_b128 v6, v[64:67] offset:768
    ds_write_b128 v6, v[68:71] offset:832
    ds_write_b128 v6, v[72:75] offset:896
    ds_write_b128 v6, v[76:79] offset:960
    ds_read_b128 v[16:19], v5 offset:0
    ds_read_b128 v[20:23], v5 offset:1088
    ds_read_b128 v[24:27], v5 offset:2176
    ds_read_b128 v[28:31], v5 offset:3264
    ds_read_b128 v[32:35], v5 offset:4352
    ds_read_b128 v[36:39], v5 offset:5440
    ds_read_b128 v[40:43], v5 offset:6528
    ds_read_b128 v[44:47], v5 offset:7616
    ds_read_b128 v[48:51], v5 offset:8704
    ds_read_b128 v[52:55], v5 offset:9792
    ds_read_b128 v[56:59], v5 offset:10880
    ds_read_b128 v[60:63], v5 offset:11968
    ds_read_b128 v[64:67], v5 offset:13056
    ds_read_b128 v[68:71], v5 offset:14144
    ds_read_b128 v[72:75], v5 offset:15232
    ds_read_b128 v[76:79], v5 offset:16320
    s_waitcnt lgkmcnt(0)
    v_mul_f32 v176, v20, v116
    v_fma_f32 v177, v21, v117, v176
    v_mul_f32 v176, v20, v117
    v_fma_f32 v178, v21, v116, -v176
    v_mul_f32 v176, v22, v118
    v_fma_f32 v179, v23, v119, v176
    v_mul_f32 v176, v22, v119
    v_fma_f32 v180, v23, v118, -v176
    v_mul_f32 v176, v24, v120
    v_fma_f32 v181, v25, v121, v176
    v_mul_f32 v176, v24, v121
    v_fma_f32 v182, v25, v120, -v176
    v_mul_f32 v176, v26, v122
    v_fma_f32 v183, v27, v123, v176
    v_mul_f32 v176, v26, v123
    v_fma_f32 v184, v27, v122, -v176
    v_mul_f32 v176, v28, v124
    v_fma_f32 v185, v29, v125, v176
    v_mul_f32 v176, v28, v125
    v_fma_f32 v186, v29, v124, -v176
    v_mul_f32 v176, v30, v126
    v_fma_f32 v187, v31, v127, v176
    v_mul_f32 v176, v30, v127
    v_fma_f32 v188, v31, v126, -v176
    v_mul_f32 v176, v32, v128
    v_fma_f32 v189, v33, v129, v176
    v_mul_f32 v176, v32, v129
    v_fma_f32 v190, v33, v128, -v176
    v_mul_f32 v176, v34, v130
    v_fma_f32 v191, v35, v131, v176
    v_mul_f32 v176, v34, v131
    v_fma_f32 v192, v35, v130, -v176
    v_mul_f32 v176, v36, v132
    v_fma_f32 v193, v37, v133, v176
    v_mul_f32 v176, v36, v133
    v_fma_f32 v194, v37, v132, -v176
    v_mul_f32 v176, v38, v134
    v_fma_f32 v195, v39, v135, v176
    v_mul_f32 v176, v38, v135
    v_fma_f32 v196, v39, v134, -v176
    v_mul_f32 v176, v40, v136
    v_fma_f32 v197, v41, v137, v176
    v_mul_f32 v176, v40, v137
    v_fma_f32 v198, v41, v136, -v176
    v_mul_f32 v176, v42, v138
    v_fma_f32 v199, v43, v139, v176
    v_mul_f32 v176, v42, v139
    v_fma_f32 v200, v43, v138, -v176
    v_mul_f32 v176, v44, v140
    v_fma_f32 v201, v45, v141, v176
    v_mul_f32 v176, v44, v141
    v_fma_f32 v202, v45, v140, -v176
    v_mul_f32 v176, v46, v142
    v_fma_f32 v203, v47, v143, v176
    v_mul_f32 v176, v46, v143
    v_fma_f32 v204, v47, v142, -v176
    v_mul_f32 v176, v48, v144
    v_fma_f32 v205, v49, v145, v176
    v_mul_f32 v176, v48, v145
    v_fma_f32 v206, v49, v144, -v176
    v_mul_f32 v176, v50, v146
    v_fma_f32 v207, v51, v147, v176
    v_mul_f32 v176, v50, v147
    v_fma_f32 v208, v51, v146, -v176
    v_mul_f32 v176, v52, v148
    v_fma_f32 v209, v53, v149, v176
    v_mul_f32 v176, v52, v149
    v_fma_f32 v210, v53, v148, -v176
    v_mul_f32 v176, v54, v150
    v_fma_f32 v211, v55, v151, v176
    v_mul_f32 v176, v54, v151
    v_fma_f32 v212, v55, v150, -v176
    v_mul_f32 v176, v56, v152
    v_fma_f32 v213, v57, v153, v176
    v_mul_f32 v176, v56, v153
    v_fma_f32 v214, v57, v152, -v176
    v_mul_f32 v176, v58, v154
    v_fma_f32 v215, v59, v155, v176
    v_mul_f32 v176, v58, v155
    v_fma_f32 v216, v59, v154, -v176
    v_mul_f32 v176, v60, v156
    v_fma_f32 v217, v61, v157, v176
    v_mul_f32 v176, v60, v157
    v_fma_f32 v218, v61, v156, -v176
    v_mul_f32 v176, v62, v158
    v_fma_f32 v219, v63, v159, v176
    v_mul_f32 v176, v62, v159
    v_fma_f32 v220, v63, v158, -v176
    v_mul_f32 v176, v64, v160
    v_fma_f32 v221, v65, v161, v176
    v_mul_f32 v176, v64, v161
    v_fma_f32 v222, v65, v160, -v176
    v_mul_f32 v176, v66, v162
    v_fma_f32 v223, v67, v163, v176
    v_mul_f32 v176, v66, v163
    v_fma_f32 v224, v67, v162, -v176
    v_mul_f32 v176, v68, v164
    v_fma_f32 v225, v69, v165, v176
    v_mul_f32 v176, v68, v165
    v_fma_f32 v226, v69, v164, -v176
    v_mul_f32 v176, v70, v166
    v_fma_f32 v227, v71, v167, v176
    v_mul_f32 v176, v70, v167
    v_fma_f32 v228, v71, v166, -v176
    v_mul_f32 v176, v72, v168
    v_fma_f32 v229, v73, v169, v176
    v_mul_f32 v176, v72, v169
    v_fma_f32 v230, v73, v168, -v176
    v_mul_f32 v176, v74, v170
    v_fma_f32 v231, v75, v171, v176
    v_mul_f32 v176, v74, v171
    v_fma_f32 v232, v75, v170, -v176
    v_mul_f32 v176, v76, v172
    v_fma_f32 v233, v77, v173, v176
    v_mul_f32 v176, v76, v173
    v_fma_f32 v234, v77, v172, -v176
    v_mul_f32 v176, v78, v174
    v_fma_f32 v235, v79, v175, v176
    v_mul_f32 v176, v78, v175
    v_fma_f32 v236, v79, v174, -v176
    v_add_f32 v176, v16, v205
    v_add_f32 v237, v17, v206
    v_sub_f32 v238, v16, v205
    v_sub_f32 v239, v17, v206
    v_add_f32 v240, v189, v221
    v_add_f32 v241, v190, v222
    v_sub_f32 v242, v189, v221
    v_sub_f32 v243, v190, v222
    v_add_f32 v189, v176, v240
    v_add_f32 v190, v237, v241
    v_sub_f32 v205, v176, v240
    v_sub_f32 v206, v237, v241
    v_sub_f32 v221, v238, v243
    v_add_f32 v222, v239, v242
    v_add_f32 v244, v238, v243
    v_sub_f32 v245, v239, v242
    v_add_f32 v176, v177, v209
    v_add_f32 v237, v178, v210
    v_sub_f32 v238, v177, v209
    v_sub_f32 v239, v178, v210
    v_add_f32 v240, v193, v225
    v_add_f32 v241, v194, v226
    v_sub_f32 v242, v193, v225
    v_sub_f32 v243, v194, v226
    v_add_f32 v177, v176, v240
    v_add_f32 v178, v237, v241
    v_sub_f32 v193, v176, v240
    v_sub_f32 v194, v237, v241
    v_sub_f32 v209, v238, v243
    v_add_f32 v210, v239, v242
    v_add_f32 v225, v238, v243
    v_sub_f32 v226, v239, v242
    v_mul_f32 v176, 0x3f6c835e, v209
    v_fmamk_f32 v237, v210, 0xbec3ef15, v176
    v_mul_f32 v176, 0x3ec3ef15, v209
    v_fmamk_f32 v238, v210, 0x3f6c835e, v176
    v_mul_f32 v176, 0x3f3504f3, v193
    v_fmamk_f32 v209, v194, 0xbf3504f3, v176
    v_mul_f32 v176, 0x3f3504f3, v193
    v_fmamk_f32 v210, v194, 0x3f3504f3, v176
    v_mul_f32 v176, 0x3ec3ef15, v225
    v_fmamk_f32 v193, v226, 0xbf6c835e, v176
    v_mul_f32 v176, 0x3f6c835e, v225
    v_fmamk_f32 v194, v226, 0x3ec3ef15, v176
    v_add_f32 v176, v181, v213
    v_add_f32 v225, v182, v214
    v_sub_f32 v226, v181, v213
    v_sub_f32 v239, v182, v214
    v_add_f32 v240, v197, v229
    v_add_f32 v241, v198, v230
    v_sub_f32 v242, v197, v229
    v_sub_f32 v243, v198, v230
    v_add_f32 v181, v176, v240
    v_add_f32 v182, v225, v241
    v_sub_f32 v197, v176, v240
    v_sub_f32 v198, v225, v241
    v_sub_f32 v213, v226, v243
    v_add_f32 v214, v239, v242
    v_add_f32 v229, v226, v243
    v_sub_f32 v230, v239, v242
    v_mul_f32 v176, 0x3f3504f3, v213
    v_fmamk_f32 v225, v214, 0xbf3504f3, v176
    v_mul_f32 v176, 0x3f3504f3, v213
    v_fmamk_f32 v226, v214, 0x3f3504f3, v176
    v_mul_f32 v176, 0xbf3504f3, v229
    v_fmamk_f32 v213, v230, 0xbf3504f3, v176
    v_mul_f32 v176, 0x3f3504f3, v229
    v_fmamk_f32 v214, v230, 0xbf3504f3, v176
    v_add_f32 v176, v185, v217
    v_add_f32 v229, v186, v218
    v_sub_f32 v230, v185, v217
    v_sub_f32 v239, v186, v218
    v_add_f32 v240, v201, v233
    v_add_f32 v241, v202, v234
    v_sub_f32 v242, v201, v233
    v_sub_f32 v243, v202, v234
    v_add_f32 v185, v176, v240
    v_add_f32 v186, v229, v241
    v_sub_f32 v201, v176, v240
    v_sub_f32 v202, v229, v241
    v_sub_f32 v217, v230, v243
    v_add_f32 v218, v239, v242
    v_add_f32 v233, v230, v243
    v_sub_f32 v234, v239, v242
    v_mul_f32 v176, 0x3ec3ef15, v217
    v_fmamk_f32 v229, v218, 0xbf6c835e, v176
    v_mul_f32 v176, 0x3f6c835e, v217
    v_fmamk_f32 v230, v218, 0x3ec3ef15, v176
    v_mul_f32 v176, 0xbf3504f3, v201
    v_fmamk_f32 v217, v202, 0xbf3504f3, v176
    v_mul_f32 v176, 0x3f3504f3, v201
    v_fmamk_f32 v218, v202, 0xbf3504f3, v176
    v_mul_f32 v176, 0xbf6c835e, v233
    v_fmamk_f32 v201, v234, 0x3ec3ef15, v176
    v_mul_f32 v176, 0xbec3ef15, v233
    v_fmamk_f32 v202, v234, 0xbf6c835e, v176
    v_add_f32 v176, v189, v181
    v_add_f32 v233, v190, v182
    v_sub_f32 v234, v189, v181
    v_sub_f32 v239, v190, v182
    v_add_f32 v240, v177, v185
    v_add_f32 v241, v178, v186
    v_sub_f32 v242, v177, v185
    v_sub_f32 v243, v178, v186
    v_add_f32 v16, v176, v240
    v_add_f32 v17, v233, v241
    v_sub_f32 v48, v176, v240
    v_sub_f32 v49, v233, v241
    v_sub_f32 v32, v234, v243
    v_add_f32 v33, v239, v242
    v_add_f32 v64, v234, v243
    v_sub_f32 v65, v239, v242
    v_add_f32 v176, v221, v225
    v_add_f32 v177, v222, v226
    v_sub_f32 v178, v221, v225
    v_sub_f32 v181, v222, v226
    v_add_f32 v182, v237, v229
    v_add_f32 v185, v238, v230
    v_sub_f32 v186, v237, v229
    v_sub_f32 v189, v238, v230
    v_add_f32 v20, v176, v182
    v_add_f32 v21, v177, v185
    v_sub_f32 v52, v176, v182
    v_sub_f32 v53, v177, v185
    v_sub_f32 v36, v178, v189
    v_add_f32 v37, v181, v186
    v_add_f32 v68, v178, v189
    v_sub_f32 v69, v181, v186
    v_sub_f32 v176, v205, v198
    v_add_f32 v177, v206, v197
    v_add_f32 v178, v205, v198
    v_sub_f32 v181, v206, v197
    v_add_f32 v182, v209, v217
    v_add_f32 v185, v210, v218
    v_sub_f32 v186, v209, v217
    v_sub_f32 v189, v210, v218
    v_add_f32 v24, v176, v182
    v_add_f32 v25, v177, v185
    v_sub_f32 v56, v176, v182
    v_sub_f32 v57, v177, v185
    v_sub_f32 v40, v178, v189
    v_add_f32 v41, v181, v186
    v_add_f32 v72, v178, v189
    v_sub_f32 v73, v181, v186
    v_add_f32 v176, v244, v213
    v_add_f32 v177, v245, v214
    v_sub_f32 v178, v244, v213
    v_sub_f32 v181, v245, v214
    v_add_f32 v182, v193, v201
    v_add_f32 v185, v194, v202
    v_sub_f32 v186, v193, v201
    v_sub_f32 v189, v194, v202
    v_add_f32 v28, v176, v182
    v_add_f32 v29, v177, v185
    v_sub_f32 v60, v176, v182
    v_sub_f32 v61, v177, v185
    v_sub_f32 v44, v178, v189
    v_add_f32 v45, v181, v186
    v_add_f32 v76, v178, v189
    v_sub_f32 v77, v181, v186
    v_add_f32 v176, v18, v207
    v_add_f32 v177, v19, v208
    v_sub_f32 v178, v18, v207
    v_sub_f32 v181, v19, v208
    v_add_f32 v182, v191, v223
    v_add_f32 v185, v192, v224
    v_sub_f32 v186, v191, v223
    v_sub_f32 v189, v192, v224
    v_add_f32 v190, v176, v182
    v_add_f32 v191, v177, v185
    v_sub_f32 v192, v176, v182
    v_sub_f32 v193, v177, v185
    v_sub_f32 v194, v178, v189
    v_add_f32 v197, v181, v186
    v_add_f32 v198, v178, v189
    v_sub_f32 v201, v181, v186
    v_add_f32 v176, v179, v211
    v_add_f32 v177, v180, v212
    v_sub_f32 v178, v179, v211
    v_sub_f32 v181, v180, v212
    v_add_f32 v182, v195, v227
    v_add_f32 v185, v196, v228
    v_sub_f32 v186, v195, v227
    v_sub_f32 v189, v196, v228
    v_add_f32 v179, v176, v182
    v_add_f32 v180, v177, v185
    v_sub_f32 v195, v176, v182
    v_sub_f32 v196, v177, v185
    v_sub_f32 v202, v178, v189
    v_add_f32 v205, v181, v186
    v_add_f32 v206, v178, v189
    v_sub_f32 v207, v181, v186
    v_mul_f32 v176, 0x3f6c835e, v202
    v_fmamk_f32 v177, v205, 0xbec3ef15, v176
    v_mul_f32 v176, 0x3ec3ef15, v202
    v_fmamk_f32 v178, v205, 0x3f6c835e, v176
    v_mul_f32 v176, 0x3f3504f3, v195
    v_fmamk_f32 v181, v196, 0xbf3504f3, v176
    v_mul_f32 v176, 0x3f3504f3, v195
    v_fmamk_f32 v182, v196, 0x3f3504f3, v176
    v_mul_f32 v176, 0x3ec3ef15, v206
    v_fmamk_f32 v185, v207, 0xbf6c835e, v176
    v_mul_f32 v176, 0x3f6c835e, v206
    v_fmamk_f32 v186, v207, 0x3ec3ef15, v176
    v_add_f32 v176, v183, v215
    v_add_f32 v189, v184, v216
    v_sub_f32 v195, v183, v215
    v_sub_f32 v196, v184, v216
    v_add_f32 v202, v199, v231
    v_add_f32 v205, v200, v232
    v_sub_f32 v206, v199, v231
    v_sub_f32 v207, v200, v232
    v_add_f32 v183, v176, v202
    v_add_f32 v184, v189, v205
    v_sub_f32 v199, v176, v202
    v_sub_f32 v200, v189, v205
    v_sub_f32 v208, v195, v207
    v_add_f32 v209, v196, v206
    v_add_f32 v210, v195, v207
    v_sub_f32 v211, v196, v206
    v_mul_f32 v176, 0x3f3504f3, v208
    v_fmamk_f32 v189, v209, 0xbf3504f3, v176
    v_mul_f32 v176, 0x3f3504f3, v208
    v_fmamk_f32 v195, v209, 0x3f3504f3, v176
    v_mul_f32 v176, 0xbf3504f3, v210
    v_fmamk_f32 v196, v211, 0xbf3504f3, v176
    v_mul_f32 v176, 0x3f3504f3, v210
    v_fmamk_f32 v202, v211, 0xbf3504f3, v176
    v_add_f32 v176, v187, v219
    v_add_f32 v205, v188, v220
    v_sub_f32 v206, v187, v219
    v_sub_f32 v207, v188, v220
    v_add_f32 v208, v203, v235
    v_add_f32 v209, v204, v236
    v_sub_f32 v210, v203, v235
    v_sub_f32 v211, v204, v236
    v_add_f32 v187, v176, v208
    v_add_f32 v188, v205, v209
    v_sub_f32 v203, v176, v208
    v_sub_f32 v204, v205, v209
    v_sub_f32 v212, v206, v211
    v_add_f32 v213, v207, v210
    v_add_f32 v214, v206, v211
    v_sub_f32 v215, v207, v210
    v_mul_f32 v176, 0x3ec3ef15, v212
    v_fmamk_f32 v205, v213, 0xbf6c835e, v176
    v_mul_f32 v176, 0x3f6c835e, v212
    v_fmamk_f32 v206, v213, 0x3ec3ef15, v176
    v_mul_f32 v176, 0xbf3504f3, v203
    v_fmamk_f32 v207, v204, 0xbf3504f3, v176
    v_mul_f32 v176, 0x3f3504f3, v203
    v_fmamk_f32 v208, v204, 0xbf3504f3, v176
    v_mul_f32 v176, 0xbf6c835e, v214
    v_fmamk_f32 v203, v215, 0x3ec3ef15, v176
    v_mul_f32 v176, 0xbec3ef15, v214
    v_fmamk_f32 v204, v215, 0xbf6c835e, v176
    v_add_f32 v176, v190, v183
    v_add_f32 v209, v191, v184
    v_sub_f32 v210, v190, v183
    v_sub_f32 v211, v191, v184
    v_add_f32 v212, v179, v187
    v_add_f32 v213, v180, v188
    v_sub_f32 v214, v179, v187
    v_sub_f32 v215, v180, v188
    v_add_f32 v18, v176, v212
    v_add_f32 v19, v209, v213
    v_sub_f32 v50, v176, v212
    v_sub_f32 v51, v209, v213
    v_sub_f32 v34, v210, v215
    v_add_f32 v35, v211, v214
    v_add_f32 v66, v210, v215
    v_sub_f32 v67, v211, v214
    v_add_f32 v176, v194, v189
    v_add_f32 v179, v197, v195
    v_sub_f32 v180, v194, v189
    v_sub_f32 v183, v197, v195
    v_add_f32 v184, v177, v205
    v_add_f32 v187, v178, v206
    v_sub_f32 v188, v177, v205
    v_sub_f32 v190, v178, v206
    v_add_f32 v22, v176, v184
    v_add_f32 v23, v179, v187
    v_sub_f32 v54, v176, v184
    v_sub_f32 v55, v179, v187
    v_sub_f32 v38, v180, v190
    v_add_f32 v39, v183, v188
    v_add_f32 v70, v180, v190
    v_sub_f32 v71, v183, v188
    v_sub_f32 v176, v192, v200
    v_add_f32 v177, v193, v199
    v_add_f32 v178, v192, v200
    v_sub_f32 v179, v193, v199
    v_add_f32 v180, v181, v207
    v_add_f32 v183, v182, v208
    v_sub_f32 v184, v181, v207
    v_sub_f32 v187, v182, v208
    v_add_f32 v26, v176, v180
    v_add_f32 v27, v177, v183
    v_sub_f32 v58, v176, v180
    v_sub_f32 v59, v177, v183
    v_sub_f32 v42, v178, v187
    v_add_f32 v43, v179, v184
    v_add_f32 v74, v178, v187
    v_sub_f32 v75, v179, v184
    v_add_f32 v176, v198, v196
    v_add_f32 v177, v201, v202
    v_sub_f32 v178, v198, v196
    v_sub_f32 v179, v201, v202
    v_add_f32 v180, v185, v203
    v_add_f32 v181, v186, v204
    v_sub_f32 v182, v185, v203
    v_sub_f32 v183, v186, v204
    v_add_f32 v30, v176, v180
    v_add_f32 v31, v177, v181
    v_sub_f32 v62, v176, v180
    v_sub_f32 v63, v177, v181
    v_sub_f32 v46, v178, v183
    v_add_f32 v47, v179, v182
    v_add_f32 v78, v178, v183
    v_sub_f32 v79, v179, v182
    v_lshrrev_b32 v15, 3, v2
    v_mul_u32_u24 v15, 37120, v15
    v_and_b32 v13, 7, v2
    v_lshlrev_b32 v13, 4, v13
    v_add_u32 v15, v15, v13
    s_lshl_b32 s38, s28, 7
    s_add_u32 s31, s38, 0
    buffer_store_dwordx4 v[16:19], v15, s[20:23], s31 offen sc0 sc1
    s_add_u32 s31, s38, 296960
    buffer_store_dwordx4 v[20:23], v15, s[20:23], s31 offen sc0 sc1
    s_add_u32 s31, s38, 593920
    buffer_store_dwordx4 v[24:27], v15, s[20:23], s31 offen sc0 sc1
    s_add_u32 s31, s38, 890880
    buffer_store_dwordx4 v[28:31], v15, s[20:23], s31 offen sc0 sc1
    s_add_u32 s31, s38, 1187840
    buffer_store_dwordx4 v[32:35], v15, s[20:23], s31 offen sc0 sc1
    s_add_u32 s31, s38, 1484800
    buffer_store_dwordx4 v[36:39], v15, s[20:23], s31 offen sc0 sc1
    s_add_u32 s31, s38, 1781760
    buffer_store_dwordx4 v[40:43], v15, s[20:23], s31 offen sc0 sc1
    s_add_u32 s31, s38, 2078720
    buffer_store_dwordx4 v[44:47], v15, s[20:23], s31 offen sc0 sc1
    s_add_u32 s31, s38, 2375680
    buffer_store_dwordx4 v[48:51], v15, s[20:23], s31 offen sc0 sc1
    s_add_u32 s31, s38, 2672640
    buffer_store_dwordx4 v[52:55], v15, s[20:23], s31 offen sc0 sc1
    s_add_u32 s31, s38, 2969600
    buffer_store_dwordx4 v[56:59], v15, s[20:23], s31 offen sc0 sc1
    s_add_u32 s31, s38, 3266560
    buffer_store_dwordx4 v[60:63], v15, s[20:23], s31 offen sc0 sc1
    s_add_u32 s31, s38, 3563520
    buffer_store_dwordx4 v[64:67], v15, s[20:23], s31 offen sc0 sc1
    s_add_u32 s31, s38, 3860480
    buffer_store_dwordx4 v[68:71], v15, s[20:23], s31 offen sc0 sc1
    s_add_u32 s31, s38, 4157440
    buffer_store_dwordx4 v[72:75], v15, s[20:23], s31 offen sc0 sc1
    s_add_u32 s31, s38, 4454400
    buffer_store_dwordx4 v[76:79], v15, s[20:23], s31 offen sc0 sc1
    s_branch L_phB_done
L_phB_done:
    s_waitcnt vmcnt(0)
L_phB_done2:
    s_load_dwordx2 s[4:5], s[0:1], 48
    s_waitcnt lgkmcnt(0)
    s_barrier
    s_cmp_lg_u32 s33, 0
    s_cbranch_scc1 L_nf_2
    s_lshl_b32 s51, s2, 7
    s_add_u32 s51, s51, 32768
    v_mov_b32 v244, 1
    v_mov_b32 v245, 0
    s_mov_b64 s[30:31], exec
    s_mov_b64 exec, 1
    buffer_store_dword v244, v245, s[56:59], s51 offen sc0 sc1
    s_mov_b64 exec, s[30:31]
L_nf_2:
    s_and_b32 s28, s2, 7
    s_lshr_b32 s29, s2, 3
    s_lshr_b32 s30, s28, 1
    s_and_b32 s31, s28, 1
    s_lshl_b32 s31, s31, 3
    s_lshr_b32 s32, s29, 2
    s_add_u32 s31, s31, s32
    s_and_b32 s32, s29, 3
    s_and_b32 s34, s33, 3
    s_lshr_b32 s35, s33, 2
    v_lshrrev_b32 v3, 4, v2
    v_and_b32 v4, 15, v2
    v_lshrrev_b32 v5, 2, v4
    v_and_b32 v6, 3, v4
    s_mov_b32 s12, s4
    s_mov_b32 s13, s5
    s_mov_b32 s14, 18874368
    s_mov_b32 s15, 0x00020000
    s_add_u32 s16, s8, 4194304
    s_addc_u32 s17, s9, 0
    s_mov_b32 s18, 5308416
    s_mov_b32 s19, 0x00020000
    s_add_u32 s20, s8, 16777216
    s_addc_u32 s21, s9, 0
    s_mov_b32 s22, 18874368
    s_mov_b32 s23, 0x00020000
    s_cmp_eq_u32 s35, 0
    s_cbranch_scc1 L_g2_compute
    s_mul_i32 s38, s30, 1152
    s_lshl_b32 s39, s34, 4
    s_add_u32 s38, s38, s39
    v_add_u32 v9, s38, v3
    v_lshlrev_b32 v9, 12, v9
    s_lshl_b32 s39, s31, 8
    v_add_u32 v9, s39, v9
    v_lshlrev_b32 v10, 1, v3
    v_xor_b32 v11, v10, v4
    v_lshlrev_b32 v11, 4, v11
    v_add_u32 v20, v9, v11
    v_xor_b32 v11, 8, v10
    v_xor_b32 v11, v11, v4
    v_lshlrev_b32 v11, 4, v11
    v_add_u32 v21, v9, v11
    s_lshl_b32 s43, s34, 12
    s_mov_b32 s42, 0
    s_mov_b32 s47, 0
    s_mul_i32 s38, s32, 9
    s_lshr_b32 s38, s38, 1
    s_mul_i32 s42, s38, 262144
    s_mul_i32 s47, s38, 73728
    s_cmp_lt_u32 s34, 2
    s_cbranch_scc1 L_g2_v1
    s_branch L_g2_v2
L_g2_v1:
    s_mul_i32 s38, s34, 320
    s_add_u32 s38, s38, 0
    v_add_u32 v9, s38, v2
    v_mul_u32_u24 v10, 3641, v9
    v_lshrrev_b32 v10, 19, v10
    v_mul_u32_u24 v11, 144, v10
    v_sub_u32 v11, v9, v11
    v_mul_u32_u24 v10, 9216, v10
    v_lshlrev_b32 v11, 4, v11
    v_add_u32 v10, v10, v11
    s_mul_i32 s38, s30, 1327104
    s_mul_i32 s39, s32, 2304
    s_add_u32 s38, s38, s39
    v_add_u32 v22, s38, v10
    s_mul_i32 s38, s34, 320
    s_add_u32 s38, s38, 64
    v_add_u32 v9, s38, v2
    v_mul_u32_u24 v10, 3641, v9
    v_lshrrev_b32 v10, 19, v10
    v_mul_u32_u24 v11, 144, v10
    v_sub_u32 v11, v9, v11
    v_mul_u32_u24 v10, 9216, v10
    v_lshlrev_b32 v11, 4, v11
    v_add_u32 v10, v10, v11
    s_mul_i32 s38, s30, 1327104
    s_mul_i32 s39, s32, 2304
    s_add_u32 s38, s38, s39
    s_sub_u32 s38, s38, 1024
    v_add_u32 v23, s38, v10
    s_mul_i32 s38, s34, 320
    s_add_u32 s38, s38, 128
    v_add_u32 v9, s38, v2
    v_mul_u32_u24 v10, 3641, v9
    v_lshrrev_b32 v10, 19, v10
    v_mul_u32_u24 v11, 144, v10
    v_sub_u32 v11, v9, v11
    v_mul_u32_u24 v10, 9216, v10
    v_lshlrev_b32 v11, 4, v11
    v_add_u32 v10, v10, v11
    s_mul_i32 s38, s30, 1327104
    s_mul_i32 s39, s32, 2304
    s_add_u32 s38, s38, s39
    s_sub_u32 s38, s38, 2048
    v_add_u32 v24, s38, v10
    s_mul_i32 s38, s34, 320
    s_add_u32 s38, s38, 192
    v_add_u32 v9, s38, v2
    v_mul_u32_u24 v10, 3641, v9
    v_lshrrev_b32 v10, 19, v10
    v_mul_u32_u24 v11, 144, v10
    v_sub_u32 v11, v9, v11
    v_mul_u32_u24 v10, 9216, v10
    v_lshlrev_b32 v11, 4, v11
    v_add_u32 v10, v10, v11
    s_mul_i32 s38, s30, 1327104
    s_mul_i32 s39, s32, 2304
    s_add_u32 s38, s38, s39
    s_sub_u32 s38, s38, 3072
    v_add_u32 v25, s38, v10
    s_mul_i32 s38, s34, 320
    s_add_u32 s38, s38, 256
    v_add_u32 v9, s38, v2
    v_mul_u32_u24 v10, 3641, v9
    v_lshrrev_b32 v10, 19, v10
    v_mul_u32_u24 v11, 144, v10
    v_sub_u32 v11, v9, v11
    v_mul_u32_u24 v10, 9216, v10
    v_lshlrev_b32 v11, 4, v11
    v_add_u32 v10, v10, v11
    s_mul_i32 s38, s30, 1327104
    s_mul_i32 s39, s32, 2304
    s_add_u32 s38, s38, s39
    v_add_u32 v26, s38, v10
    s_mul_i32 s46, s34, 5120
    s_add_u32 s46, s46, 16384
    s_mov_b32 s40, 0
    s_add_u32 m0, s40, s43
    s_add_u32 s44, s42, 0
    buffer_load_dwordx4 v20, s[12:15], s44 offen offset:0 lds
    s_add_u32 s44, s42, 15360
    buffer_load_dwordx4 v20, s[12:15], s44 offen offset:1024 lds
    s_add_u32 s44, s42, 30720
    buffer_load_dwordx4 v21, s[12:15], s44 offen offset:2048 lds
    s_add_u32 s44, s42, 46080
    buffer_load_dwordx4 v21, s[12:15], s44 offen offset:3072 lds
    s_add_u32 s42, s42, 262144
    s_cmp_eq_u32 s42, 4718592
    s_cselect_b32 s42, 0, s42
    s_mov_b32 s40, 34816
    s_add_u32 m0, s40, s43
    s_add_u32 s44, s42, 0
    buffer_load_dwordx4 v20, s[12:15], s44 offen offset:0 lds
    s_add_u32 s44, s42, 15360
    buffer_load_dwordx4 v20, s[12:15], s44 offen offset:1024 lds
    s_add_u32 s44, s42, 30720
    buffer_load_dwordx4 v21, s[12:15], s44 offen offset:2048 lds
    s_add_u32 s44, s42, 46080
    buffer_load_dwordx4 v21, s[12:15], s44 offen offset:3072 lds
    s_add_u32 s42, s42, 262144
    s_cmp_eq_u32 s42, 4718592
    s_cselect_b32 s42, 0, s42
    s_mov_b32 s40, 69632
    s_add_u32 m0, s40, s43
    s_add_u32 s44, s42, 0
    buffer_load_dwordx4 v20, s[12:15], s44 offen offset:0 lds
    s_add_u32 s44, s42, 15360
    buffer_load_dwordx4 v20, s[12:15], s44 offen offset:1024 lds
    s_add_u32 s44, s42, 30720
    buffer_load_dwordx4 v21, s[12:15], s44 offen offset:2048 lds
    s_add_u32 s44, s42, 46080
    buffer_load_dwordx4 v21, s[12:15], s44 offen offset:3072 lds
    s_add_u32 s42, s42, 262144
    s_cmp_eq_u32 s42, 4718592
    s_cselect_b32 s42, 0, s42
    s_mov_b32 s40, 104448
    s_add_u32 m0, s40, s43
    s_add_u32 s44, s42, 0
    buffer_load_dwordx4 v20, s[12:15], s44 offen offset:0 lds
    s_add_u32 s44, s42, 15360
    buffer_load_dwordx4 v20, s[12:15], s44 offen offset:1024 lds
    s_add_u32 s44, s42, 30720
    buffer_load_dwordx4 v21, s[12:15], s44 offen offset:2048 lds
    s_add_u32 s44, s42, 46080
    buffer_load_dwordx4 v21, s[12:15], s44 offen offset:3072 lds
    s_add_u32 s42, s42, 262144
    s_cmp_eq_u32 s42, 4718592
    s_cselect_b32 s42, 0, s42
    s_barrier
    s_mov_b32 s40, 0
    s_add_u32 m0, s40, s46
    s_nop 0
    buffer_load_dwordx4 v22, s[16:19], s47 offen offset:0 lds
    buffer_load_dwordx4 v23, s[16:19], s47 offen offset:1024 lds
    buffer_load_dwordx4 v24, s[16:19], s47 offen offset:2048 lds
    buffer_load_dwordx4 v25, s[16:19], s47 offen offset:3072 lds
    s_add_u32 m0, m0, 4096
    s_nop 0
    buffer_load_dwordx4 v26, s[16:19], s47 offen offset:0 lds
    s_add_u32 s47, s47, 73728
    s_cmp_eq_u32 s47, 1327104
    s_cselect_b32 s47, 0, s47
    s_mov_b32 s40, 34816
    s_add_u32 m0, s40, s46
    s_nop 0
    buffer_load_dwordx4 v22, s[16:19], s47 offen offset:0 lds
    buffer_load_dwordx4 v23, s[16:19], s47 offen offset:1024 lds
    buffer_load_dwordx4 v24, s[16:19], s47 offen offset:2048 lds
    buffer_load_dwordx4 v25, s[16:19], s47 offen offset:3072 lds
    s_add_u32 m0, m0, 4096
    s_nop 0
    buffer_load_dwordx4 v26, s[16:19], s47 offen offset:0 lds
    s_add_u32 s47, s47, 73728
    s_cmp_eq_u32 s47, 1327104
    s_cselect_b32 s47, 0, s47
    s_mov_b32 s40, 69632
    s_add_u32 m0, s40, s46
    s_nop 0
    buffer_load_dwordx4 v22, s[16:19], s47 offen offset:0 lds
    buffer_load_dwordx4 v23, s[16:19], s47 offen offset:1024 lds
    buffer_load_dwordx4 v24, s[16:19], s47 offen offset:2048 lds
    buffer_load_dwordx4 v25, s[16:19], s47 offen offset:3072 lds
    s_add_u32 m0, m0, 4096
    s_nop 0
    buffer_load_dwordx4 v26, s[16:19], s47 offen offset:0 lds
    s_add_u32 s47, s47, 73728
    s_cmp_eq_u32 s47, 1327104
    s_cselect_b32 s47, 0, s47
    s_mov_b32 s40, 104448
    s_add_u32 m0, s40, s46
    s_nop 0
    buffer_load_dwordx4 v22, s[16:19], s47 offen offset:0 lds
    buffer_load_dwordx4 v23, s[16:19], s47 offen offset:1024 lds
    buffer_load_dwordx4 v24, s[16:19], s47 offen offset:2048 lds
    buffer_load_dwordx4 v25, s[16:19], s47 offen offset:3072 lds
    s_add_u32 m0, m0, 4096
    s_nop 0
    buffer_load_dwordx4 v26, s[16:19], s47 offen offset:0 lds
    s_add_u32 s47, s47, 73728
    s_cmp_eq_u32 s47, 1327104
    s_cselect_b32 s47, 0, s47
    s_waitcnt vmcnt(15)
    s_barrier
    s_mov_b32 s40, 0
    s_waitcnt vmcnt(10)
    s_barrier
    s_add_u32 m0, s40, s43
    s_add_u32 s44, s42, 0
    buffer_load_dwordx4 v20, s[12:15], s44 offen offset:0 lds
    s_add_u32 s44, s42, 15360
    buffer_load_dwordx4 v20, s[12:15], s44 offen offset:1024 lds
    s_add_u32 s44, s42, 30720
    buffer_load_dwordx4 v21, s[12:15], s44 offen offset:2048 lds
    s_add_u32 s44, s42, 46080
    buffer_load_dwordx4 v21, s[12:15], s44 offen offset:3072 lds
    s_add_u32 s42, s42, 262144
    s_cmp_eq_u32 s42, 4718592
    s_cselect_b32 s42, 0, s42
    s_add_u32 m0, s40, s46
    s_nop 0
    buffer_load_dwordx4 v22, s[16:19], s47 offen offset:0 lds
    buffer_load_dwordx4 v23, s[16:19], s47 offen offset:1024 lds
    buffer_load_dwordx4 v24, s[16:19], s47 offen offset:2048 lds
    buffer_load_dwordx4 v25, s[16:19], s47 offen offset:3072 lds
    s_add_u32 m0, m0, 4096
    s_nop 0
    buffer_load_dwordx4 v26, s[16:19], s47 offen offset:0 lds
    s_add_u32 s47, s47, 73728
    s_cmp_eq_u32 s47, 1327104
    s_cselect_b32 s47, 0, s47
    s_add_u32 s40, s40, 34816
    s_cmp_eq_u32 s40, 139264
    s_cselect_b32 s40, 0, s40
    s_waitcnt vmcnt(14)
    s_barrier
    s_add_u32 m0, s40, s43
    s_add_u32 s44, s42, 0
    buffer_load_dwordx4 v20, s[12:15], s44 offen offset:0 lds
    s_add_u32 s44, s42, 15360
    buffer_load_dwordx4 v20, s[12:15], s44 offen offset:1024 lds
    s_add_u32 s44, s42, 30720
    buffer_load_dwordx4 v21, s[12:15], s44 offen offset:2048 lds
    s_add_u32 s44, s42, 46080
    buffer_load_dwordx4 v21, s[12:15], s44 offen offset:3072 lds
    s_add_u32 s42, s42, 262144
    s_cmp_eq_u32 s42, 4718592
    s_cselect_b32 s42, 0, s42
    s_add_u32 m0, s40, s46
    s_nop 0
    buffer_load_dwordx4 v22, s[16:19], s47 offen offset:0 lds
    buffer_load_dwordx4 v23, s[16:19], s47 offen offset:1024 lds
    buffer_load_dwordx4 v24, s[16:19], s47 offen offset:2048 lds
    buffer_load_dwordx4 v25, s[16:19], s47 offen offset:3072 lds
    s_add_u32 m0, m0, 4096
    s_nop 0
    buffer_load_dwordx4 v26, s[16:19], s47 offen offset:0 lds
    s_add_u32 s47, s47, 73728
    s_cmp_eq_u32 s47, 1327104
    s_cselect_b32 s47, 0, s47
    s_add_u32 s40, s40, 34816
    s_cmp_eq_u32 s40, 139264
    s_cselect_b32 s40, 0, s40
    s_mov_b32 s45, 12
L_g2v1_ld:
    s_waitcnt vmcnt(18)
    s_barrier
    s_add_u32 m0, s40, s43
    s_add_u32 s44, s42, 0
    buffer_load_dwordx4 v20, s[12:15], s44 offen offset:0 lds
    s_add_u32 s44, s42, 15360
    buffer_load_dwordx4 v20, s[12:15], s44 offen offset:1024 lds
    s_add_u32 s44, s42, 30720
    buffer_load_dwordx4 v21, s[12:15], s44 offen offset:2048 lds
    s_add_u32 s44, s42, 46080
    buffer_load_dwordx4 v21, s[12:15], s44 offen offset:3072 lds
    s_add_u32 s42, s42, 262144
    s_cmp_eq_u32 s42, 4718592
    s_cselect_b32 s42, 0, s42
    s_add_u32 m0, s40, s46
    s_nop 0
    buffer_load_dwordx4 v22, s[16:19], s47 offen offset:0 lds
    buffer_load_dwordx4 v23, s[16:19], s47 offen offset:1024 lds
    buffer_load_dwordx4 v24, s[16:19], s47 offen offset:2048 lds
    buffer_load_dwordx4 v25, s[16:19], s47 offen offset:3072 lds
    s_add_u32 m0, m0, 4096
    s_nop 0
    buffer_load_dwordx4 v26, s[16:19], s47 offen offset:0 lds
    s_add_u32 s47, s47, 73728
    s_cmp_eq_u32 s47, 1327104
    s_cselect_b32 s47, 0, s47
    s_add_u32 s40, s40, 34816
    s_cmp_eq_u32 s40, 139264
    s_cselect_b32 s40, 0, s40
    s_sub_u32 s45, s45, 1
    s_cmp_lg_u32 s45, 0
    s_cbranch_scc1 L_g2v1_ld
    s_waitcnt vmcnt(18)
    s_barrier
    s_waitcnt vmcnt(9)
    s_barrier
    s_waitcnt vmcnt(0)
    s_barrier
    s_waitcnt vmcnt(0)
    s_barrier
    s_branch L_phC_done
L_g2_v2:
    s_lshl_b32 s38, s34, 8
    s_add_u32 s38, s38, 128
    v_add_u32 v9, s38, v2
    v_mul_u32_u24 v10, 3641, v9
    v_lshrrev_b32 v10, 19, v10
    v_mul_u32_u24 v11, 144, v10
    v_sub_u32 v11, v9, v11
    v_mul_u32_u24 v10, 9216, v10
    v_lshlrev_b32 v11, 4, v11
    v_add_u32 v10, v10, v11
    s_mul_i32 s38, s30, 1327104
    s_mul_i32 s39, s32, 2304
    s_add_u32 s38, s38, s39
    v_add_u32 v22, s38, v10
    s_lshl_b32 s38, s34, 8
    s_add_u32 s38, s38, 192
    v_add_u32 v9, s38, v2
    v_mul_u32_u24 v10, 3641, v9
    v_lshrrev_b32 v10, 19, v10
    v_mul_u32_u24 v11, 144, v10
    v_sub_u32 v11, v9, v11
    v_mul_u32_u24 v10, 9216, v10
    v_lshlrev_b32 v11, 4, v11
    v_add_u32 v10, v10, v11
    s_mul_i32 s38, s30, 1327104
    s_mul_i32 s39, s32, 2304
    s_add_u32 s38, s38, s39
    s_sub_u32 s38, s38, 1024
    v_add_u32 v23, s38, v10
    s_lshl_b32 s38, s34, 8
    s_add_u32 s38, s38, 256
    v_add_u32 v9, s38, v2
    v_mul_u32_u24 v10, 3641, v9
    v_lshrrev_b32 v10, 19, v10
    v_mul_u32_u24 v11, 144, v10
    v_sub_u32 v11, v9, v11
    v_mul_u32_u24 v10, 9216, v10
    v_lshlrev_b32 v11, 4, v11
    v_add_u32 v10, v10, v11
    s_mul_i32 s38, s30, 1327104
    s_mul_i32 s39, s32, 2304
    s_add_u32 s38, s38, s39
    s_sub_u32 s38, s38, 2048
    v_add_u32 v24, s38, v10
    s_lshl_b32 s38, s34, 8
    s_add_u32 s38, s38, 320
    v_add_u32 v9, s38, v2
    v_mul_u32_u24 v10, 3641, v9
    v_lshrrev_b32 v10, 19, v10
    v_mul_u32_u24 v11, 144, v10
    v_sub_u32 v11, v9, v11
    v_mul_u32_u24 v10, 9216, v10
    v_lshlrev_b32 v11, 4, v11
    v_add_u32 v10, v10, v11
    s_mul_i32 s38, s30, 1327104
    s_mul_i32 s39, s32, 2304
    s_add_u32 s38, s38, s39
    s_sub_u32 s38, s38, 3072
    v_add_u32 v25, s38, v10
    s_lshl_b32 s46, s34, 12
    s_add_u32 s46, s46, 18432
    s_mov_b32 s40, 0
    s_add_u32 m0, s40, s43
    s_add_u32 s44, s42, 0
    buffer_load_dwordx4 v20, s[12:15], s44 offen offset:0 lds
    s_add_u32 s44, s42, 15360
    buffer_load_dwordx4 v20, s[12:15], s44 offen offset:1024 lds
    s_add_u32 s44, s42, 30720
    buffer_load_dwordx4 v21, s[12:15], s44 offen offset:2048 lds
    s_add_u32 s44, s42, 46080
    buffer_load_dwordx4 v21, s[12:15], s44 offen offset:3072 lds
    s_add_u32 s42, s42, 262144
    s_cmp_eq_u32 s42, 4718592
    s_cselect_b32 s42, 0, s42
    s_mov_b32 s40, 34816
    s_add_u32 m0, s40, s43
    s_add_u32 s44, s42, 0
    buffer_load_dwordx4 v20, s[12:15], s44 offen offset:0 lds
    s_add_u32 s44, s42, 15360
    buffer_load_dwordx4 v20, s[12:15], s44 offen offset:1024 lds
    s_add_u32 s44, s42, 30720
    buffer_load_dwordx4 v21, s[12:15], s44 offen offset:2048 lds
    s_add_u32 s44, s42, 46080
    buffer_load_dwordx4 v21, s[12:15], s44 offen offset:3072 lds
    s_add_u32 s42, s42, 262144
    s_cmp_eq_u32 s42, 4718592
    s_cselect_b32 s42, 0, s42
    s_mov_b32 s40, 69632
    s_add_u32 m0, s40, s43
    s_add_u32 s44, s42, 0
    buffer_load_dwordx4 v20, s[12:15], s44 offen offset:0 lds
    s_add_u32 s44, s42, 15360
    buffer_load_dwordx4 v20, s[12:15], s44 offen offset:1024 lds
    s_add_u32 s44, s42, 30720
    buffer_load_dwordx4 v21, s[12:15], s44 offen offset:2048 lds
    s_add_u32 s44, s42, 46080
    buffer_load_dwordx4 v21, s[12:15], s44 offen offset:3072 lds
    s_add_u32 s42, s42, 262144
    s_cmp_eq_u32 s42, 4718592
    s_cselect_b32 s42, 0, s42
    s_mov_b32 s40, 104448
    s_add_u32 m0, s40, s43
    s_add_u32 s44, s42, 0
    buffer_load_dwordx4 v20, s[12:15], s44 offen offset:0 lds
    s_add_u32 s44, s42, 15360
    buffer_load_dwordx4 v20, s[12:15], s44 offen offset:1024 lds
    s_add_u32 s44, s42, 30720
    buffer_load_dwordx4 v21, s[12:15], s44 offen offset:2048 lds
    s_add_u32 s44, s42, 46080
    buffer_load_dwordx4 v21, s[12:15], s44 offen offset:3072 lds
    s_add_u32 s42, s42, 262144
    s_cmp_eq_u32 s42, 4718592
    s_cselect_b32 s42, 0, s42
    s_cmp_lg_u32 s33, 7
    s_cbranch_scc1 L_c2_go
    v_mov_b32 v252, 0
    v_mov_b32 v253, 0
    v_mov_b32 v254, 0
    v_cmp_le_u32 vcc, 24, v2
    s_nop 1
    v_cndmask_b32 v255, 0, 1, vcc
    v_lshlrev_b32 v248, 7, v2
    s_mov_b32 s50, 400000
L_poll_u:
    s_mov_b32 s51, 32768
    buffer_load_dword v244, v248, s[56:59], s51 offen sc0 sc1
    s_mov_b32 s51, 40960
    buffer_load_dword v245, v248, s[56:59], s51 offen sc0 sc1
    s_mov_b32 s51, 49152
    buffer_load_dword v246, v248, s[56:59], s51 offen sc0 sc1
    s_mov_b32 s51, 57344
    buffer_load_dword v247, v248, s[56:59], s51 offen sc0 sc1
    s_waitcnt vmcnt(0)
    v_or_b32 v244, v244, v252
    v_or_b32 v245, v245, v253
    v_min_u32 v244, v244, v245
    v_or_b32 v246, v246, v254
    v_min_u32 v244, v244, v246
    v_or_b32 v247, v247, v255
    v_min_u32 v244, v244, v247
    v_cmp_eq_u32 vcc, 0, v244
    s_sub_u32 s50, s50, 1
    s_cmp_eq_u32 s50, 0
    s_cbranch_scc1 L_pollx_u
    s_cmp_eq_u64 vcc, 0
    s_cbranch_scc1 L_pollx_u
    s_sleep 2
    s_branch L_poll_u
L_pollx_u:
L_c2_go:
    s_barrier
    s_mov_b32 s40, 0
    s_add_u32 m0, s40, s46
    s_nop 0
    buffer_load_dwordx4 v22, s[16:19], s47 offen offset:0 lds
    buffer_load_dwordx4 v23, s[16:19], s47 offen offset:1024 lds
    buffer_load_dwordx4 v24, s[16:19], s47 offen offset:2048 lds
    buffer_load_dwordx4 v25, s[16:19], s47 offen offset:3072 lds
    s_add_u32 s47, s47, 73728
    s_cmp_eq_u32 s47, 1327104
    s_cselect_b32 s47, 0, s47
    s_mov_b32 s40, 34816
    s_add_u32 m0, s40, s46
    s_nop 0
    buffer_load_dwordx4 v22, s[16:19], s47 offen offset:0 lds
    buffer_load_dwordx4 v23, s[16:19], s47 offen offset:1024 lds
    buffer_load_dwordx4 v24, s[16:19], s47 offen offset:2048 lds
    buffer_load_dwordx4 v25, s[16:19], s47 offen offset:3072 lds
    s_add_u32 s47, s47, 73728
    s_cmp_eq_u32 s47, 1327104
    s_cselect_b32 s47, 0, s47
    s_mov_b32 s40, 69632
    s_add_u32 m0, s40, s46
    s_nop 0
    buffer_load_dwordx4 v22, s[16:19], s47 offen offset:0 lds
    buffer_load_dwordx4 v23, s[16:19], s47 offen offset:1024 lds
    buffer_load_dwordx4 v24, s[16:19], s47 offen offset:2048 lds
    buffer_load_dwordx4 v25, s[16:19], s47 offen offset:3072 lds
    s_add_u32 s47, s47, 73728
    s_cmp_eq_u32 s47, 1327104
    s_cselect_b32 s47, 0, s47
    s_mov_b32 s40, 104448
    s_add_u32 m0, s40, s46
    s_nop 0
    buffer_load_dwordx4 v22, s[16:19], s47 offen offset:0 lds
    buffer_load_dwordx4 v23, s[16:19], s47 offen offset:1024 lds
    buffer_load_dwordx4 v24, s[16:19], s47 offen offset:2048 lds
    buffer_load_dwordx4 v25, s[16:19], s47 offen offset:3072 lds
    s_add_u32 s47, s47, 73728
    s_cmp_eq_u32 s47, 1327104
    s_cselect_b32 s47, 0, s47
    s_waitcnt vmcnt(12)
    s_barrier
    s_mov_b32 s40, 0
    s_waitcnt vmcnt(8)
    s_barrier
    s_add_u32 m0, s40, s43
    s_add_u32 s44, s42, 0
    buffer_load_dwordx4 v20, s[12:15], s44 offen offset:0 lds
    s_add_u32 s44, s42, 15360
    buffer_load_dwordx4 v20, s[12:15], s44 offen offset:1024 lds
    s_add_u32 s44, s42, 30720
    buffer_load_dwordx4 v21, s[12:15], s44 offen offset:2048 lds
    s_add_u32 s44, s42, 46080
    buffer_load_dwordx4 v21, s[12:15], s44 offen offset:3072 lds
    s_add_u32 s42, s42, 262144
    s_cmp_eq_u32 s42, 4718592
    s_cselect_b32 s42, 0, s42
    s_add_u32 m0, s40, s46
    s_nop 0
    buffer_load_dwordx4 v22, s[16:19], s47 offen offset:0 lds
    buffer_load_dwordx4 v23, s[16:19], s47 offen offset:1024 lds
    buffer_load_dwordx4 v24, s[16:19], s47 offen offset:2048 lds
    buffer_load_dwordx4 v25, s[16:19], s47 offen offset:3072 lds
    s_add_u32 s47, s47, 73728
    s_cmp_eq_u32 s47, 1327104
    s_cselect_b32 s47, 0, s47
    s_add_u32 s40, s40, 34816
    s_cmp_eq_u32 s40, 139264
    s_cselect_b32 s40, 0, s40
    s_waitcnt vmcnt(12)
    s_barrier
    s_add_u32 m0, s40, s43
    s_add_u32 s44, s42, 0
    buffer_load_dwordx4 v20, s[12:15], s44 offen offset:0 lds
    s_add_u32 s44, s42, 15360
    buffer_load_dwordx4 v20, s[12:15], s44 offen offset:1024 lds
    s_add_u32 s44, s42, 30720
    buffer_load_dwordx4 v21, s[12:15], s44 offen offset:2048 lds
    s_add_u32 s44, s42, 46080
    buffer_load_dwordx4 v21, s[12:15], s44 offen offset:3072 lds
    s_add_u32 s42, s42, 262144
    s_cmp_eq_u32 s42, 4718592
    s_cselect_b32 s42, 0, s42
    s_add_u32 m0, s40, s46
    s_nop 0
    buffer_load_dwordx4 v22, s[16:19], s47 offen offset:0 lds
    buffer_load_dwordx4 v23, s[16:19], s47 offen offset:1024 lds
    buffer_load_dwordx4 v24, s[16:19], s47 offen offset:2048 lds
    buffer_load_dwordx4 v25, s[16:19], s47 offen offset:3072 lds
    s_add_u32 s47, s47, 73728
    s_cmp_eq_u32 s47, 1327104
    s_cselect_b32 s47, 0, s47
    s_add_u32 s40, s40, 34816
    s_cmp_eq_u32 s40, 139264
    s_cselect_b32 s40, 0, s40
    s_mov_b32 s45, 12
L_g2v2_ld:
    s_waitcnt vmcnt(16)
    s_barrier
    s_add_u32 m0, s40, s43
    s_add_u32 s44, s42, 0
    buffer_load_dwordx4 v20, s[12:15], s44 offen offset:0 lds
    s_add_u32 s44, s42, 15360
    buffer_load_dwordx4 v20, s[12:15], s44 offen offset:1024 lds
    s_add_u32 s44, s42, 30720
    buffer_load_dwordx4 v21, s[12:15], s44 offen offset:2048 lds
    s_add_u32 s44, s42, 46080
    buffer_load_dwordx4 v21, s[12:15], s44 offen offset:3072 lds
    s_add_u32 s42, s42, 262144
    s_cmp_eq_u32 s42, 4718592
    s_cselect_b32 s42, 0, s42
    s_add_u32 m0, s40, s46
    s_nop 0
    buffer_load_dwordx4 v22, s[16:19], s47 offen offset:0 lds
    buffer_load_dwordx4 v23, s[16:19], s47 offen offset:1024 lds
    buffer_load_dwordx4 v24, s[16:19], s47 offen offset:2048 lds
    buffer_load_dwordx4 v25, s[16:19], s47 offen offset:3072 lds
    s_add_u32 s47, s47, 73728
    s_cmp_eq_u32 s47, 1327104
    s_cselect_b32 s47, 0, s47
    s_add_u32 s40, s40, 34816
    s_cmp_eq_u32 s40, 139264
    s_cselect_b32 s40, 0, s40
    s_sub_u32 s45, s45, 1
    s_cmp_lg_u32 s45, 0
    s_cbranch_scc1 L_g2v2_ld
    s_waitcnt vmcnt(16)
    s_barrier
    s_waitcnt vmcnt(8)
    s_barrier
    s_waitcnt vmcnt(0)
    s_barrier
    s_waitcnt vmcnt(0)
    s_barrier
    s_branch L_phC_done
L_g2_compute:
    v_and_b32 v7, 1, v3
    v_lshlrev_b32 v7, 2, v7
    v_or_b32 v7, v7, v5
    v_lshlrev_b32 v8, 3, v3
    v_add_u32 v8, v8, v5
    v_lshlrev_b32 v8, 8, v8
    v_lshlrev_b32 v9, 3, v6
    v_add_u32 v8, v8, v9
    s_lshl_b32 s38, s34, 1
    s_add_u32 s39, s38, 0
    v_xor_b32 v9, s39, v7
    v_lshlrev_b32 v9, 5, v9
    v_add_u32 v100, v8, v9
    s_add_u32 s39, s38, 1
    v_xor_b32 v9, s39, v7
    v_lshlrev_b32 v9, 5, v9
    v_add_u32 v101, v8, v9
    v_mul_u32_u24 v9, 144, v3
    v_add_u32 v9, v9, v4
    v_lshlrev_b32 v9, 4, v9
    v_add_u32 v102, 16384, v9
    v_mov_b32 v16, 0
    v_mov_b32 v17, 0
    v_mov_b32 v18, 0
    v_mov_b32 v19, 0
    v_mov_b32 v20, 0
    v_mov_b32 v21, 0
    v_mov_b32 v22, 0
    v_mov_b32 v23, 0
    v_mov_b32 v24, 0
    v_mov_b32 v25, 0
    v_mov_b32 v26, 0
    v_mov_b32 v27, 0
    v_mov_b32 v28, 0
    v_mov_b32 v29, 0
    v_mov_b32 v30, 0
    v_mov_b32 v31, 0
    v_mov_b32 v32, 0
    v_mov_b32 v33, 0
    v_mov_b32 v34, 0
    v_mov_b32 v35, 0
    v_mov_b32 v36, 0
    v_mov_b32 v37, 0
    v_mov_b32 v38, 0
    v_mov_b32 v39, 0
    v_mov_b32 v40, 0
    v_mov_b32 v41, 0
    v_mov_b32 v42, 0
    v_mov_b32 v43, 0
    v_mov_b32 v44, 0
    v_mov_b32 v45, 0
    v_mov_b32 v46, 0
    v_mov_b32 v47, 0
    v_mov_b32 v48, 0
    v_mov_b32 v49, 0
    v_mov_b32 v50, 0
    v_mov_b32 v51, 0
    v_mov_b32 v52, 0
    v_mov_b32 v53, 0
    v_mov_b32 v54, 0
    v_mov_b32 v55, 0
    v_mov_b32 v56, 0
    v_mov_b32 v57, 0
    v_mov_b32 v58, 0
    v_mov_b32 v59, 0
    v_mov_b32 v60, 0
    v_mov_b32 v61, 0
    v_mov_b32 v62, 0
    v_mov_b32 v63, 0
    v_mov_b32 v64, 0
    v_mov_b32 v65, 0
    v_mov_b32 v66, 0
    v_mov_b32 v67, 0
    v_mov_b32 v68, 0
    v_mov_b32 v69, 0
    v_mov_b32 v70, 0
    v_mov_b32 v71, 0
    v_mov_b32 v72, 0
    v_mov_b32 v73, 0
    v_mov_b32 v74, 0
    v_mov_b32 v75, 0
    v_mov_b32 v76, 0
    v_mov_b32 v77, 0
    v_mov_b32 v78, 0
    v_mov_b32 v79, 0
    v_mov_b32 v80, 0
    v_mov_b32 v81, 0
    v_mov_b32 v82, 0
    v_mov_b32 v83, 0
    v_mov_b32 v84, 0
    v_mov_b32 v85, 0
    v_mov_b32 v86, 0
    v_mov_b32 v87, 0
    s_barrier
    s_barrier
    s_mov_b32 s41, 0
    v_add_u32 v103, s41, v100
    v_add_u32 v104, s41, v101
    v_add_u32 v105, s41, v102
    ds_read_b64_tr_b16 v[112:113], v103 offset:0
    ds_read_b64_tr_b16 v[114:115], v103 offset:1024
    ds_read_b64_tr_b16 v[116:117], v104 offset:0
    ds_read_b64_tr_b16 v[118:119], v104 offset:1024
    ds_read_b128 v[120:123], v105 offset:0
    ds_read_b128 v[124:127], v105 offset:256
    ds_read_b128 v[128:131], v105 offset:512
    ds_read_b128 v[132:135], v105 offset:768
    ds_read_b128 v[136:139], v105 offset:1024
    ds_read_b128 v[140:143], v105 offset:1280
    ds_read_b128 v[144:147], v105 offset:1536
    ds_read_b128 v[148:151], v105 offset:1792
    ds_read_b128 v[152:155], v105 offset:2048
    s_mov_b32 s45, 17
L_g2_cp:
    s_waitcnt lgkmcnt(0)
    v_mfma_f32_16x16x32_bf16 v[16:19], v[120:123], v[112:115], v[16:19]
    ds_read_b64_tr_b16 v[156:157], v103 offset:8192
    ds_read_b64_tr_b16 v[158:159], v103 offset:9216
    v_mfma_f32_16x16x32_bf16 v[20:23], v[120:123], v[116:119], v[20:23]
    ds_read_b64_tr_b16 v[160:161], v104 offset:8192
    ds_read_b64_tr_b16 v[162:163], v104 offset:9216
    v_mfma_f32_16x16x32_bf16 v[24:27], v[124:127], v[112:115], v[24:27]
    ds_read_b128 v[164:167], v105 offset:9216
    ds_read_b128 v[168:171], v105 offset:9472
    v_mfma_f32_16x16x32_bf16 v[28:31], v[124:127], v[116:119], v[28:31]
    ds_read_b128 v[172:175], v105 offset:9728
    ds_read_b128 v[176:179], v105 offset:9984
    v_mfma_f32_16x16x32_bf16 v[32:35], v[128:131], v[112:115], v[32:35]
    ds_read_b128 v[180:183], v105 offset:10240
    ds_read_b128 v[184:187], v105 offset:10496
    v_mfma_f32_16x16x32_bf16 v[36:39], v[128:131], v[116:119], v[36:39]
    ds_read_b128 v[188:191], v105 offset:10752
    ds_read_b128 v[192:195], v105 offset:11008
    v_mfma_f32_16x16x32_bf16 v[40:43], v[132:135], v[112:115], v[40:43]
    ds_read_b128 v[196:199], v105 offset:11264
    v_mfma_f32_16x16x32_bf16 v[44:47], v[132:135], v[116:119], v[44:47]
    v_mfma_f32_16x16x32_bf16 v[48:51], v[136:139], v[112:115], v[48:51]
    v_mfma_f32_16x16x32_bf16 v[52:55], v[136:139], v[116:119], v[52:55]
    v_mfma_f32_16x16x32_bf16 v[56:59], v[140:143], v[112:115], v[56:59]
    v_mfma_f32_16x16x32_bf16 v[60:63], v[140:143], v[116:119], v[60:63]
    v_mfma_f32_16x16x32_bf16 v[64:67], v[144:147], v[112:115], v[64:67]
    v_mfma_f32_16x16x32_bf16 v[68:71], v[144:147], v[116:119], v[68:71]
    v_mfma_f32_16x16x32_bf16 v[72:75], v[148:151], v[112:115], v[72:75]
    v_mfma_f32_16x16x32_bf16 v[76:79], v[148:151], v[116:119], v[76:79]
    v_mfma_f32_16x16x32_bf16 v[80:83], v[152:155], v[112:115], v[80:83]
    v_mfma_f32_16x16x32_bf16 v[84:87], v[152:155], v[116:119], v[84:87]
    s_add_u32 s41, s41, 34816
    s_cmp_eq_u32 s41, 139264
    s_cselect_b32 s41, 0, s41
    v_add_u32 v103, s41, v100
    v_add_u32 v104, s41, v101
    v_add_u32 v105, s41, v102
    s_waitcnt lgkmcnt(0)
    s_barrier
    v_mfma_f32_16x16x32_bf16 v[16:19], v[164:167], v[156:159], v[16:19]
    ds_read_b64_tr_b16 v[112:113], v103 offset:0
    ds_read_b64_tr_b16 v[114:115], v103 offset:1024
    v_mfma_f32_16x16x32_bf16 v[20:23], v[164:167], v[160:163], v[20:23]
    ds_read_b64_tr_b16 v[116:117], v104 offset:0
    ds_read_b64_tr_b16 v[118:119], v104 offset:1024
    v_mfma_f32_16x16x32_bf16 v[24:27], v[168:171], v[156:159], v[24:27]
    ds_read_b128 v[120:123], v105 offset:0
    ds_read_b128 v[124:127], v105 offset:256
    v_mfma_f32_16x16x32_bf16 v[28:31], v[168:171], v[160:163], v[28:31]
    ds_read_b128 v[128:131], v105 offset:512
    ds_read_b128 v[132:135], v105 offset:768
    v_mfma_f32_16x16x32_bf16 v[32:35], v[172:175], v[156:159], v[32:35]
    ds_read_b128 v[136:139], v105 offset:1024
    ds_read_b128 v[140:143], v105 offset:1280
    v_mfma_f32_16x16x32_bf16 v[36:39], v[172:175], v[160:163], v[36:39]
    ds_read_b128 v[144:147], v105 offset:1536
    ds_read_b128 v[148:151], v105 offset:1792
    v_mfma_f32_16x16x32_bf16 v[40:43], v[176:179], v[156:159], v[40:43]
    ds_read_b128 v[152:155], v105 offset:2048
    v_mfma_f32_16x16x32_bf16 v[44:47], v[176:179], v[160:163], v[44:47]
    v_mfma_f32_16x16x32_bf16 v[48:51], v[180:183], v[156:159], v[48:51]
    v_mfma_f32_16x16x32_bf16 v[52:55], v[180:183], v[160:163], v[52:55]
    v_mfma_f32_16x16x32_bf16 v[56:59], v[184:187], v[156:159], v[56:59]
    v_mfma_f32_16x16x32_bf16 v[60:63], v[184:187], v[160:163], v[60:63]
    v_mfma_f32_16x16x32_bf16 v[64:67], v[188:191], v[156:159], v[64:67]
    v_mfma_f32_16x16x32_bf16 v[68:71], v[188:191], v[160:163], v[68:71]
    v_mfma_f32_16x16x32_bf16 v[72:75], v[192:195], v[156:159], v[72:75]
    v_mfma_f32_16x16x32_bf16 v[76:79], v[192:195], v[160:163], v[76:79]
    v_mfma_f32_16x16x32_bf16 v[80:83], v[196:199], v[156:159], v[80:83]
    v_mfma_f32_16x16x32_bf16 v[84:87], v[196:199], v[160:163], v[84:87]
    s_sub_u32 s45, s45, 1
    s_cmp_lg_u32 s45, 0
    s_cbranch_scc1 L_g2_cp
    s_waitcnt lgkmcnt(0)
    v_mfma_f32_16x16x32_bf16 v[16:19], v[120:123], v[112:115], v[16:19]
    ds_read_b64_tr_b16 v[156:157], v103 offset:8192
    ds_read_b64_tr_b16 v[158:159], v103 offset:9216
    v_mfma_f32_16x16x32_bf16 v[20:23], v[120:123], v[116:119], v[20:23]
    ds_read_b64_tr_b16 v[160:161], v104 offset:8192
    ds_read_b64_tr_b16 v[162:163], v104 offset:9216
    v_mfma_f32_16x16x32_bf16 v[24:27], v[124:127], v[112:115], v[24:27]
    ds_read_b128 v[164:167], v105 offset:9216
    ds_read_b128 v[168:171], v105 offset:9472
    v_mfma_f32_16x16x32_bf16 v[28:31], v[124:127], v[116:119], v[28:31]
    ds_read_b128 v[172:175], v105 offset:9728
    ds_read_b128 v[176:179], v105 offset:9984
    v_mfma_f32_16x16x32_bf16 v[32:35], v[128:131], v[112:115], v[32:35]
    ds_read_b128 v[180:183], v105 offset:10240
    ds_read_b128 v[184:187], v105 offset:10496
    v_mfma_f32_16x16x32_bf16 v[36:39], v[128:131], v[116:119], v[36:39]
    ds_read_b128 v[188:191], v105 offset:10752
    ds_read_b128 v[192:195], v105 offset:11008
    v_mfma_f32_16x16x32_bf16 v[40:43], v[132:135], v[112:115], v[40:43]
    ds_read_b128 v[196:199], v105 offset:11264
    v_mfma_f32_16x16x32_bf16 v[44:47], v[132:135], v[116:119], v[44:47]
    v_mfma_f32_16x16x32_bf16 v[48:51], v[136:139], v[112:115], v[48:51]
    v_mfma_f32_16x16x32_bf16 v[52:55], v[136:139], v[116:119], v[52:55]
    v_mfma_f32_16x16x32_bf16 v[56:59], v[140:143], v[112:115], v[56:59]
    v_mfma_f32_16x16x32_bf16 v[60:63], v[140:143], v[116:119], v[60:63]
    v_mfma_f32_16x16x32_bf16 v[64:67], v[144:147], v[112:115], v[64:67]
    v_mfma_f32_16x16x32_bf16 v[68:71], v[144:147], v[116:119], v[68:71]
    v_mfma_f32_16x16x32_bf16 v[72:75], v[148:151], v[112:115], v[72:75]
    v_mfma_f32_16x16x32_bf16 v[76:79], v[148:151], v[116:119], v[76:79]
    v_mfma_f32_16x16x32_bf16 v[80:83], v[152:155], v[112:115], v[80:83]
    v_mfma_f32_16x16x32_bf16 v[84:87], v[152:155], v[116:119], v[84:87]
    s_waitcnt lgkmcnt(0)
    s_barrier
    v_mfma_f32_16x16x32_bf16 v[16:19], v[164:167], v[156:159], v[16:19]
    v_mfma_f32_16x16x32_bf16 v[20:23], v[164:167], v[160:163], v[20:23]
    v_mfma_f32_16x16x32_bf16 v[24:27], v[168:171], v[156:159], v[24:27]
    v_mfma_f32_16x16x32_bf16 v[28:31], v[168:171], v[160:163], v[28:31]
    v_mfma_f32_16x16x32_bf16 v[32:35], v[172:175], v[156:159], v[32:35]
    v_mfma_f32_16x16x32_bf16 v[36:39], v[172:175], v[160:163], v[36:39]
    v_mfma_f32_16x16x32_bf16 v[40:43], v[176:179], v[156:159], v[40:43]
    v_mfma_f32_16x16x32_bf16 v[44:47], v[176:179], v[160:163], v[44:47]
    v_mfma_f32_16x16x32_bf16 v[48:51], v[180:183], v[156:159], v[48:51]
    v_mfma_f32_16x16x32_bf16 v[52:55], v[180:183], v[160:163], v[52:55]
    v_mfma_f32_16x16x32_bf16 v[56:59], v[184:187], v[156:159], v[56:59]
    v_mfma_f32_16x16x32_bf16 v[60:63], v[184:187], v[160:163], v[60:63]
    v_mfma_f32_16x16x32_bf16 v[64:67], v[188:191], v[156:159], v[64:67]
    v_mfma_f32_16x16x32_bf16 v[68:71], v[188:191], v[160:163], v[68:71]
    v_mfma_f32_16x16x32_bf16 v[72:75], v[192:195], v[156:159], v[72:75]
    v_mfma_f32_16x16x32_bf16 v[76:79], v[192:195], v[160:163], v[76:79]
    v_mfma_f32_16x16x32_bf16 v[80:83], v[196:199], v[156:159], v[80:83]
    v_mfma_f32_16x16x32_bf16 v[84:87], v[196:199], v[160:163], v[84:87]
    s_lshl_b32 s38, s30, 11
    s_lshl_b32 s39, s31, 7
    s_add_u32 s38, s38, s39
    s_lshl_b32 s39, s34, 5
    s_add_u32 s38, s38, s39
    v_add_u32 v12, s38, v4
    s_mov_b32 s39, 2304
    v_mul_lo_u32 v12, v12, s39
    s_mul_i32 s38, s32, 576
    v_add_u32 v12, s38, v12
    v_lshlrev_b32 v13, 4, v3
    v_add_u32 v12, v12, v13
    s_mov_b32 s39, 36864
    s_nop 3
    buffer_store_dwordx4 v[16:19], v12, s[20:23], 0 offen offset:0 sc0 sc1
    buffer_store_dwordx4 v[20:23], v12, s[20:23], s39 offen offset:0 sc0 sc1
    buffer_store_dwordx4 v[24:27], v12, s[20:23], 0 offen offset:64 sc0 sc1
    buffer_store_dwordx4 v[28:31], v12, s[20:23], s39 offen offset:64 sc0 sc1
    buffer_store_dwordx4 v[32:35], v12, s[20:23], 0 offen offset:128 sc0 sc1
    buffer_store_dwordx4 v[36:39], v12, s[20:23], s39 offen offset:128 sc0 sc1
    buffer_store_dwordx4 v[40:43], v12, s[20:23], 0 offen offset:192 sc0 sc1
    buffer_store_dwordx4 v[44:47], v12, s[20:23], s39 offen offset:192 sc0 sc1
    buffer_store_dwordx4 v[48:51], v12, s[20:23], 0 offen offset:256 sc0 sc1
    buffer_store_dwordx4 v[52:55], v12, s[20:23], s39 offen offset:256 sc0 sc1
    buffer_store_dwordx4 v[56:59], v12, s[20:23], 0 offen offset:320 sc0 sc1
    buffer_store_dwordx4 v[60:63], v12, s[20:23], s39 offen offset:320 sc0 sc1
    buffer_store_dwordx4 v[64:67], v12, s[20:23], 0 offen offset:384 sc0 sc1
    buffer_store_dwordx4 v[68:71], v12, s[20:23], s39 offen offset:384 sc0 sc1
    buffer_store_dwordx4 v[72:75], v12, s[20:23], 0 offen offset:448 sc0 sc1
    buffer_store_dwordx4 v[76:79], v12, s[20:23], s39 offen offset:448 sc0 sc1
    buffer_store_dwordx4 v[80:83], v12, s[20:23], 0 offen offset:512 sc0 sc1
    buffer_store_dwordx4 v[84:87], v12, s[20:23], s39 offen offset:512 sc0 sc1
L_phC_done:
    s_mov_b32 s40, s33
    s_load_dwordx2 s[4:5], s[0:1], 0
    s_load_dwordx2 s[6:7], s[0:1], 56
    s_load_dwordx2 s[10:11], s[0:1], 64
    s_add_u32 s36, s8, 67108864
    s_addc_u32 s37, s9, 0
    s_mov_b32 s38, 4751360
    s_mov_b32 s39, 0x00020000
    s_add_u32 s20, s8, 16777216
    s_addc_u32 s21, s9, 0
    s_mov_b32 s22, 18874368
    s_mov_b32 s23, 0x00020000
    v_mul_u32_u24 v3, 911, v0
    v_lshrrev_b32 v3, 16, v3
    v_mul_u32_u24 v4, 72, v3
    v_sub_u32 v4, v0, v4
    v_lshrrev_b32 v5, 3, v4
    v_and_b32 v6, 7, v4
    v_mul_u32_u24 v7, 5184, v3
    v_mul_u32_u24 v8, 576, v5
    v_add_u32 v7, v7, v8
    s_cmp_lg_u32 s33, 7
    s_cbranch_scc1 L_d_go
    v_add_u32 v255, 192, v2
    v_subrev_u32 v255, 216, v255
    v_cmp_lt_u32 vcc, 36, v255
    s_nop 1
    v_cndmask_b32 v255, 0, 1, vcc
    v_lshlrev_b32 v248, 7, v2
    s_mov_b32 s50, 400000
L_poll_z:
    s_mov_b32 s51, 57344
    buffer_load_dword v247, v248, s[56:59], s51 offen sc0 sc1
    s_waitcnt vmcnt(0)
    v_or_b32 v247, v247, v255
    v_cmp_eq_u32 vcc, 0, v247
    s_sub_u32 s50, s50, 1
    s_cmp_eq_u32 s50, 0
    s_cbranch_scc1 L_pollx_z
    s_cmp_eq_u64 vcc, 0
    s_cbranch_scc1 L_pollx_z
    s_sleep 2
    s_branch L_poll_z
L_pollx_z:
L_d_go:
    s_barrier
    s_lshr_b32 s42, s2, 1
    s_mul_i32 s42, s42, 37120
    s_and_b32 s43, s2, 1
    s_lshl_b32 s43, s43, 6
    s_add_u32 s42, s42, s43
    v_add_u32 v10, 0, v0
    v_lshrrev_b32 v11, 2, v10
    v_lshlrev_b32 v11, 7, v11
    v_and_b32 v12, 3, v10
    v_lshlrev_b32 v12, 4, v12
    v_add_u32 v13, v11, v12
    buffer_load_dwordx4 v[100:103], v13, s[36:39], s42 offen
    v_add_u32 v10, 512, v0
    v_lshrrev_b32 v11, 2, v10
    v_lshlrev_b32 v11, 7, v11
    v_and_b32 v12, 3, v10
    v_lshlrev_b32 v12, 4, v12
    v_add_u32 v13, v11, v12
    buffer_load_dwordx4 v[104:107], v13, s[36:39], s42 offen
    v_add_u32 v10, 1024, v0
    v_lshrrev_b32 v11, 2, v10
    v_lshlrev_b32 v11, 7, v11
    v_and_b32 v12, 3, v10
    v_lshlrev_b32 v12, 4, v12
    v_add_u32 v13, v11, v12
    buffer_load_dwordx4 v[108:111], v13, s[36:39], s42 offen
    v_cvt_f32_u32 v60, v6
    v_mul_f32 v61, 0x3c800000, v60
    v_cos_f32 v82, v61
    v_sin_f32 v83, v61
    v_mul_f32 v61, 0x3d000000, v60
    v_cos_f32 v84, v61
    v_sin_f32 v85, v61
    v_mul_f32 v61, 0x3d400000, v60
    v_cos_f32 v86, v61
    v_sin_f32 v87, v61
    v_mul_f32 v61, 0x3d800000, v60
    v_cos_f32 v88, v61
    v_sin_f32 v89, v61
    v_mul_f32 v61, 0x3da00000, v60
    v_cos_f32 v90, v61
    v_sin_f32 v91, v61
    v_mul_f32 v61, 0x3dc00000, v60
    v_cos_f32 v92, v61
    v_sin_f32 v93, v61
    v_mul_f32 v61, 0x3de00000, v60
    v_cos_f32 v94, v61
    v_sin_f32 v95, v61
    s_waitcnt vmcnt(0) lgkmcnt(0)
    s_mov_b32 s12, s4
    s_mov_b32 s13, s5
    s_mov_b32 s14, 2359296
    s_mov_b32 s15, 0x00020000
    s_mov_b32 s16, s6
    s_mov_b32 s17, s7
    s_mov_b32 s18, 4096
    s_mov_b32 s19, 0x00020000
    s_mov_b32 s24, s10
    s_mov_b32 s25, s11
    s_mov_b32 s26, 2359296
    s_mov_b32 s27, 0x00020000
    v_add_u32 v10, 0, v0
    v_lshrrev_b32 v11, 2, v10
    v_and_b32 v12, 3, v10
    v_mul_u32_u24 v13, 4672, v12
    v_cmp_eq_u32 vcc, 0, v11
    v_mov_b32 v17, 288
    v_cmp_eq_u32 s[28:29], v17, v11
    s_or_b64 vcc, vcc, s[28:29]
    v_sub_u32 v14, 576, v11
    v_lshlrev_b32 v18, 3, v11
    v_cndmask_b32_e64 v101, v101, 0, vcc
    v_cndmask_b32_e64 v103, v103, 0, vcc
    v_add_u32 v18, v18, v13
    v_lshlrev_b32 v14, 3, v14
    v_add_u32 v14, v14, v13
    v_sub_f32 v20, v100, v103
    v_add_f32 v21, v101, v102
    v_add_f32 v22, v100, v103
    v_sub_f32 v23, v102, v101
    ds_write_b64 v18, v[20:21] offset:0
    ds_write_b64 v14, v[22:23] offset:0
    v_add_u32 v10, 512, v0
    v_lshrrev_b32 v11, 2, v10
    v_and_b32 v12, 3, v10
    v_mul_u32_u24 v13, 4672, v12
    v_cmp_eq_u32 vcc, 0, v11
    v_mov_b32 v17, 288
    v_cmp_eq_u32 s[28:29], v17, v11
    s_or_b64 vcc, vcc, s[28:29]
    v_sub_u32 v14, 576, v11
    v_lshlrev_b32 v18, 3, v11
    v_cndmask_b32_e64 v105, v105, 0, vcc
    v_cndmask_b32_e64 v107, v107, 0, vcc
    v_add_u32 v18, v18, v13
    v_lshlrev_b32 v14, 3, v14
    v_add_u32 v14, v14, v13
    v_sub_f32 v20, v104, v107
    v_add_f32 v21, v105, v106
    v_add_f32 v22, v104, v107
    v_sub_f32 v23, v106, v105
    ds_write_b64 v18, v[20:21] offset:0
    ds_write_b64 v14, v[22:23] offset:0
    v_add_u32 v10, 1024, v0
    v_cmp_gt_u32 vcc, 1156, v10
    s_and_saveexec_b64 s[30:31], vcc
    v_lshrrev_b32 v11, 2, v10
    v_and_b32 v12, 3, v10
    v_mul_u32_u24 v13, 4672, v12
    v_cmp_eq_u32 vcc, 0, v11
    v_mov_b32 v17, 288
    v_cmp_eq_u32 s[28:29], v17, v11
    s_or_b64 vcc, vcc, s[28:29]
    v_sub_u32 v14, 576, v11
    v_lshlrev_b32 v18, 3, v11
    v_cndmask_b32_e64 v109, v109, 0, vcc
    v_cndmask_b32_e64 v111, v111, 0, vcc
    v_add_u32 v18, v18, v13
    v_lshlrev_b32 v14, 3, v14
    v_add_u32 v14, v14, v13
    v_sub_f32 v20, v108, v111
    v_add_f32 v21, v109, v110
    v_add_f32 v22, v108, v111
    v_sub_f32 v23, v110, v109
    ds_write_b64 v18, v[20:21] offset:0
    ds_write_b64 v14, v[22:23] offset:0
    s_mov_b64 exec, s[30:31]
    s_waitcnt lgkmcnt(0)
    s_barrier
    s_cmp_ge_u32 s33, 5
    s_cbranch_scc1 L_d_red
    v_cmp_gt_u32 vcc, 288, v0
    s_and_saveexec_b64 s[30:31], vcc
    v_mul_u32_u24 v22, 4672, v3
    v_mul_u32_u24 v23, 9, v6
    v_add_u32 v23, v23, v5
    v_lshlrev_b32 v23, 3, v23
    v_add_u32 v22, v22, v23
    ds_read_b64 v[30:31], v22 offset:0
    ds_read_b64 v[32:33], v22 offset:576
    ds_read_b64 v[34:35], v22 offset:1152
    ds_read_b64 v[36:37], v22 offset:1728
    ds_read_b64 v[38:39], v22 offset:2304
    ds_read_b64 v[40:41], v22 offset:2880
    ds_read_b64 v[42:43], v22 offset:3456
    ds_read_b64 v[44:45], v22 offset:4032
    v_lshlrev_b32 v20, 3, v6
    v_add_u32 v20, v7, v20
    v_mul_u32_u24 v21, 72, v6
    v_add_u32 v21, v7, v21
    s_waitcnt lgkmcnt(0)
    v_add_f32 v200, v30, v38
    v_add_f32 v201, v31, v39
    v_sub_f32 v202, v30, v38
    v_sub_f32 v203, v31, v39
    v_add_f32 v204, v32, v40
    v_add_f32 v205, v33, v41
    v_sub_f32 v206, v32, v40
    v_sub_f32 v207, v33, v41
    v_mul_f32 v208, 0x3f3504f3, v206
    v_fmamk_f32 v209, v207, 0xbf3504f3, v208
    v_mul_f32 v208, 0x3f3504f3, v206
    v_fmamk_f32 v210, v207, 0x3f3504f3, v208
    v_add_f32 v206, v34, v42
    v_add_f32 v207, v35, v43
    v_sub_f32 v208, v34, v42
    v_sub_f32 v211, v35, v43
    v_add_f32 v212, v36, v44
    v_add_f32 v213, v37, v45
    v_sub_f32 v214, v36, v44
    v_sub_f32 v215, v37, v45
    v_mul_f32 v216, 0xbf3504f3, v214
    v_fmamk_f32 v217, v215, 0xbf3504f3, v216
    v_mul_f32 v216, 0x3f3504f3, v214
    v_fmamk_f32 v218, v215, 0xbf3504f3, v216
    v_add_f32 v214, v200, v206
    v_add_f32 v215, v201, v207
    v_sub_f32 v216, v200, v206
    v_sub_f32 v219, v201, v207
    v_add_f32 v220, v204, v212
    v_add_f32 v221, v205, v213
    v_sub_f32 v222, v204, v212
    v_sub_f32 v223, v205, v213
    v_add_f32 v200, v214, v220
    v_add_f32 v201, v215, v221
    v_sub_f32 v204, v214, v220
    v_sub_f32 v205, v215, v221
    v_sub_f32 v206, v216, v223
    v_add_f32 v207, v219, v222
    v_add_f32 v212, v216, v223
    v_sub_f32 v213, v219, v222
    v_sub_f32 v214, v202, v211
    v_add_f32 v215, v203, v208
    v_add_f32 v216, v202, v211
    v_sub_f32 v219, v203, v208
    v_add_f32 v220, v209, v217
    v_add_f32 v221, v210, v218
    v_sub_f32 v222, v209, v217
    v_sub_f32 v223, v210, v218
    v_add_f32 v202, v214, v220
    v_add_f32 v203, v215, v221
    v_sub_f32 v208, v214, v220
    v_sub_f32 v209, v215, v221
    v_sub_f32 v210, v216, v223
    v_add_f32 v211, v219, v222
    v_add_f32 v217, v216, v223
    v_sub_f32 v218, v219, v222
    v_mov_b32 v60, v200
    v_mov_b32 v61, v201
    v_mul_f32 v200, v202, v82
    v_fma_f32 v62, -v203, v83, v200
    v_mul_f32 v200, v202, v83
    v_fma_f32 v63, v203, v82, v200
    v_mul_f32 v200, v206, v84
    v_fma_f32 v64, -v207, v85, v200
    v_mul_f32 v200, v206, v85
    v_fma_f32 v65, v207, v84, v200
    v_mul_f32 v200, v210, v86
    v_fma_f32 v66, -v211, v87, v200
    v_mul_f32 v200, v210, v87
    v_fma_f32 v67, v211, v86, v200
    v_mul_f32 v200, v204, v88
    v_fma_f32 v68, -v205, v89, v200
    v_mul_f32 v200, v204, v89
    v_fma_f32 v69, v205, v88, v200
    v_mul_f32 v200, v208, v90
    v_fma_f32 v70, -v209, v91, v200
    v_mul_f32 v200, v208, v91
    v_fma_f32 v71, v209, v90, v200
    v_mul_f32 v200, v212, v92
    v_fma_f32 v72, -v213, v93, v200
    v_mul_f32 v200, v212, v93
    v_fma_f32 v73, v213, v92, v200
    v_mul_f32 v200, v217, v94
    v_fma_f32 v74, -v218, v95, v200
    v_mul_f32 v200, v217, v95
    v_fma_f32 v75, v218, v94, v200
    ds_write_b64 v20, v[60:61] offset:20736
    ds_write_b64 v20, v[62:63] offset:20808
    ds_write_b64 v20, v[64:65] offset:20880
    ds_write_b64 v20, v[66:67] offset:20952
    ds_write_b64 v20, v[68:69] offset:21024
    ds_write_b64 v20, v[70:71] offset:21096
    ds_write_b64 v20, v[72:73] offset:21168
    ds_write_b64 v20, v[74:75] offset:21240
    s_waitcnt lgkmcnt(0)
    s_barrier
    ds_read_b64 v[30:31], v21 offset:20736
    ds_read_b64 v[32:33], v21 offset:20744
    ds_read_b64 v[34:35], v21 offset:20752
    ds_read_b64 v[36:37], v21 offset:20760
    ds_read_b64 v[38:39], v21 offset:20768
    ds_read_b64 v[40:41], v21 offset:20776
    ds_read_b64 v[42:43], v21 offset:20784
    ds_read_b64 v[44:45], v21 offset:20792
    s_waitcnt lgkmcnt(0)
    v_add_f32 v200, v30, v38
    v_add_f32 v201, v31, v39
    v_sub_f32 v202, v30, v38
    v_sub_f32 v203, v31, v39
    v_add_f32 v204, v32, v40
    v_add_f32 v205, v33, v41
    v_sub_f32 v206, v32, v40
    v_sub_f32 v207, v33, v41
    v_mul_f32 v208, 0x3f3504f3, v206
    v_fmamk_f32 v209, v207, 0xbf3504f3, v208
    v_mul_f32 v208, 0x3f3504f3, v206
    v_fmamk_f32 v210, v207, 0x3f3504f3, v208
    v_add_f32 v206, v34, v42
    v_add_f32 v207, v35, v43
    v_sub_f32 v208, v34, v42
    v_sub_f32 v211, v35, v43
    v_add_f32 v212, v36, v44
    v_add_f32 v213, v37, v45
    v_sub_f32 v214, v36, v44
    v_sub_f32 v215, v37, v45
    v_mul_f32 v216, 0xbf3504f3, v214
    v_fmamk_f32 v217, v215, 0xbf3504f3, v216
    v_mul_f32 v216, 0x3f3504f3, v214
    v_fmamk_f32 v218, v215, 0xbf3504f3, v216
    v_add_f32 v214, v200, v206
    v_add_f32 v215, v201, v207
    v_sub_f32 v216, v200, v206
    v_sub_f32 v219, v201, v207
    v_add_f32 v220, v204, v212
    v_add_f32 v221, v205, v213
    v_sub_f32 v222, v204, v212
    v_sub_f32 v223, v205, v213
    v_add_f32 v60, v214, v220
    v_add_f32 v61, v215, v221
    v_sub_f32 v68, v214, v220
    v_sub_f32 v69, v215, v221
    v_sub_f32 v64, v216, v223
    v_add_f32 v65, v219, v222
    v_add_f32 v72, v216, v223
    v_sub_f32 v73, v219, v222
    v_sub_f32 v200, v202, v211
    v_add_f32 v201, v203, v208
    v_add_f32 v204, v202, v211
    v_sub_f32 v205, v203, v208
    v_add_f32 v206, v209, v217
    v_add_f32 v207, v210, v218
    v_sub_f32 v212, v209, v217
    v_sub_f32 v213, v210, v218
    v_add_f32 v62, v200, v206
    v_add_f32 v63, v201, v207
    v_sub_f32 v70, v200, v206
    v_sub_f32 v71, v201, v207
    v_sub_f32 v66, v204, v213
    v_add_f32 v67, v205, v212
    v_add_f32 v74, v204, v213
    v_sub_f32 v75, v205, v212
    ds_write_b64 v20, v[60:61] offset:0
    ds_write_b64 v20, v[62:63] offset:64
    ds_write_b64 v20, v[64:65] offset:128
    ds_write_b64 v20, v[66:67] offset:192
    ds_write_b64 v20, v[68:69] offset:256
    ds_write_b64 v20, v[70:71] offset:320
    ds_write_b64 v20, v[72:73] offset:384
    ds_write_b64 v20, v[74:75] offset:448
    s_mov_b64 exec, s[30:31]
    v_cvt_f32_u32 v60, v2
    v_mul_f32 v61, 0x3ae38e39, v60
    v_cos_f32 v82, v61
    v_sin_f32 v83, v61
    v_mul_f32 v61, 0x3b638e39, v60
    v_cos_f32 v84, v61
    v_sin_f32 v85, v61
    v_mul_f32 v61, 0x3baaaaab, v60
    v_cos_f32 v86, v61
    v_sin_f32 v87, v61
    v_mul_f32 v61, 0x3be38e39, v60
    v_cos_f32 v88, v61
    v_sin_f32 v89, v61
    v_mul_f32 v61, 0x3c0e38e4, v60
    v_cos_f32 v90, v61
    v_sin_f32 v91, v61
    v_mul_f32 v61, 0x3c2aaaab, v60
    v_cos_f32 v92, v61
    v_sin_f32 v93, v61
    v_mul_f32 v61, 0x3c471c72, v60
    v_cos_f32 v94, v61
    v_sin_f32 v95, v61
    v_mul_f32 v61, 0x3c638e39, v60
    v_cos_f32 v96, v61
    v_sin_f32 v97, v61
    s_waitcnt lgkmcnt(0)
    s_barrier
    s_cmp_ge_u32 s40, 4
    s_cbranch_scc1 L_d_skip1
    s_mul_i32 s43, s40, 5184
    v_lshlrev_b32 v10, 3, v2
    v_add_u32 v10, s43, v10
    ds_read_b64 v[30:31], v10 offset:0
    ds_read_b64 v[32:33], v10 offset:576
    ds_read_b64 v[34:35], v10 offset:1152
    ds_read_b64 v[36:37], v10 offset:1728
    ds_read_b64 v[38:39], v10 offset:2304
    ds_read_b64 v[40:41], v10 offset:2880
    ds_read_b64 v[42:43], v10 offset:3456
    ds_read_b64 v[44:45], v10 offset:4032
    ds_read_b64 v[46:47], v10 offset:4608
    s_waitcnt lgkmcnt(0)
    v_mul_f32 v200, v32, v82
    v_fma_f32 v201, -v33, v83, v200
    v_mul_f32 v200, v32, v83
    v_fma_f32 v202, v33, v82, v200
    v_mul_f32 v200, v34, v84
    v_fma_f32 v203, -v35, v85, v200
    v_mul_f32 v200, v34, v85
    v_fma_f32 v204, v35, v84, v200
    v_mul_f32 v200, v36, v86
    v_fma_f32 v205, -v37, v87, v200
    v_mul_f32 v200, v36, v87
    v_fma_f32 v206, v37, v86, v200
    v_mul_f32 v200, v38, v88
    v_fma_f32 v207, -v39, v89, v200
    v_mul_f32 v200, v38, v89
    v_fma_f32 v208, v39, v88, v200
    v_mul_f32 v200, v40, v90
    v_fma_f32 v209, -v41, v91, v200
    v_mul_f32 v200, v40, v91
    v_fma_f32 v210, v41, v90, v200
    v_mul_f32 v200, v42, v92
    v_fma_f32 v211, -v43, v93, v200
    v_mul_f32 v200, v42, v93
    v_fma_f32 v212, v43, v92, v200
    v_mul_f32 v200, v44, v94
    v_fma_f32 v213, -v45, v95, v200
    v_mul_f32 v200, v44, v95
    v_fma_f32 v214, v45, v94, v200
    v_mul_f32 v200, v46, v96
    v_fma_f32 v215, -v47, v97, v200
    v_mul_f32 v200, v46, v97
    v_fma_f32 v216, v47, v96, v200
    v_add_f32 v200, v205, v211
    v_add_f32 v217, v206, v212
    v_sub_f32 v218, v205, v211
    v_sub_f32 v219, v206, v212
    v_add_f32 v205, v30, v200
    v_add_f32 v206, v31, v217
    v_fmamk_f32 v211, v200, 0xbf000000, v30
    v_fmamk_f32 v212, v217, 0xbf000000, v31
    v_fmamk_f32 v200, v219, 0xbf5db3d7, v211
    v_fmamk_f32 v217, v218, 0x3f5db3d7, v212
    v_fmamk_f32 v220, v219, 0x3f5db3d7, v211
    v_fmamk_f32 v221, v218, 0xbf5db3d7, v212
    v_add_f32 v211, v207, v213
    v_add_f32 v212, v208, v214
    v_sub_f32 v218, v207, v213
    v_sub_f32 v219, v208, v214
    v_add_f32 v207, v201, v211
    v_add_f32 v208, v202, v212
    v_fmamk_f32 v213, v211, 0xbf000000, v201
    v_fmamk_f32 v214, v212, 0xbf000000, v202
    v_fmamk_f32 v201, v219, 0xbf5db3d7, v213
    v_fmamk_f32 v202, v218, 0x3f5db3d7, v214
    v_fmamk_f32 v211, v219, 0x3f5db3d7, v213
    v_fmamk_f32 v212, v218, 0xbf5db3d7, v214
    v_mul_f32 v213, 0x3f441b7d, v201
    v_fmamk_f32 v214, v202, 0xbf248dbb, v213
    v_mul_f32 v213, 0x3f248dbb, v201
    v_fmamk_f32 v218, v202, 0x3f441b7d, v213
    v_mul_f32 v201, 0x3e31d0d4, v211
    v_fmamk_f32 v202, v212, 0xbf7c1c5c, v201
    v_mul_f32 v201, 0x3f7c1c5c, v211
    v_fmamk_f32 v213, v212, 0x3e31d0d4, v201
    v_add_f32 v201, v209, v215
    v_add_f32 v211, v210, v216
    v_sub_f32 v212, v209, v215
    v_sub_f32 v219, v210, v216
    v_add_f32 v209, v203, v201
    v_add_f32 v210, v204, v211
    v_fmamk_f32 v215, v201, 0xbf000000, v203
    v_fmamk_f32 v216, v211, 0xbf000000, v204
    v_fmamk_f32 v201, v219, 0xbf5db3d7, v215
    v_fmamk_f32 v203, v212, 0x3f5db3d7, v216
    v_fmamk_f32 v204, v219, 0x3f5db3d7, v215
    v_fmamk_f32 v211, v212, 0xbf5db3d7, v216
    v_mul_f32 v212, 0x3e31d0d4, v201
    v_fmamk_f32 v215, v203, 0xbf7c1c5c, v212
    v_mul_f32 v212, 0x3f7c1c5c, v201
    v_fmamk_f32 v216, v203, 0x3e31d0d4, v212
    v_mul_f32 v201, 0xbf708fb2, v204
    v_fmamk_f32 v203, v211, 0xbeaf1d44, v201
    v_mul_f32 v201, 0x3eaf1d44, v204
    v_fmamk_f32 v212, v211, 0xbf708fb2, v201
    v_add_f32 v201, v207, v209
    v_add_f32 v204, v208, v210
    v_sub_f32 v211, v207, v209
    v_sub_f32 v219, v208, v210
    v_add_f32 v60, v205, v201
    v_add_f32 v61, v206, v204
    v_fmamk_f32 v207, v201, 0xbf000000, v205
    v_fmamk_f32 v208, v204, 0xbf000000, v206
    v_fmamk_f32 v66, v219, 0xbf5db3d7, v207
    v_fmamk_f32 v67, v211, 0x3f5db3d7, v208
    v_fmamk_f32 v72, v219, 0x3f5db3d7, v207
    v_fmamk_f32 v73, v211, 0xbf5db3d7, v208
    v_add_f32 v201, v214, v215
    v_add_f32 v204, v218, v216
    v_sub_f32 v205, v214, v215
    v_sub_f32 v206, v218, v216
    v_add_f32 v62, v200, v201
    v_add_f32 v63, v217, v204
    v_fmamk_f32 v207, v201, 0xbf000000, v200
    v_fmamk_f32 v208, v204, 0xbf000000, v217
    v_fmamk_f32 v68, v206, 0xbf5db3d7, v207
    v_fmamk_f32 v69, v205, 0x3f5db3d7, v208
    v_fmamk_f32 v74, v206, 0x3f5db3d7, v207
    v_fmamk_f32 v75, v205, 0xbf5db3d7, v208
    v_add_f32 v200, v202, v203
    v_add_f32 v201, v213, v212
    v_sub_f32 v204, v202, v203
    v_sub_f32 v205, v213, v212
    v_add_f32 v64, v220, v200
    v_add_f32 v65, v221, v201
    v_fmamk_f32 v202, v200, 0xbf000000, v220
    v_fmamk_f32 v203, v201, 0xbf000000, v221
    v_fmamk_f32 v70, v205, 0xbf5db3d7, v202
    v_fmamk_f32 v71, v204, 0x3f5db3d7, v203
    v_fmamk_f32 v76, v205, 0x3f5db3d7, v202
    v_fmamk_f32 v77, v204, 0xbf5db3d7, v203
    v_mul_f32 v60, 0x34e38e39, v60
    v_mul_f32 v61, 0x34e38e39, v61
    v_cvt_pk_bf16_f32 v17, v60, v61
    v_lshlrev_b32 v60, 16, v17
    v_and_b32 v61, 0xffff0000, v17
    v_mul_f32 v62, 0x34e38e39, v62
    v_mul_f32 v63, 0x34e38e39, v63
    v_cvt_pk_bf16_f32 v18, v62, v63
    v_lshlrev_b32 v62, 16, v18
    v_and_b32 v63, 0xffff0000, v18
    v_mul_f32 v64, 0x34e38e39, v64
    v_mul_f32 v65, 0x34e38e39, v65
    v_cvt_pk_bf16_f32 v17, v64, v65
    v_lshlrev_b32 v64, 16, v17
    v_and_b32 v65, 0xffff0000, v17
    v_mul_f32 v66, 0x34e38e39, v66
    v_mul_f32 v67, 0x34e38e39, v67
    v_cvt_pk_bf16_f32 v18, v66, v67
    v_lshlrev_b32 v66, 16, v18
    v_and_b32 v67, 0xffff0000, v18
    v_mul_f32 v68, 0x34e38e39, v68
    v_mul_f32 v69, 0x34e38e39, v69
    v_cvt_pk_bf16_f32 v17, v68, v69
    v_lshlrev_b32 v68, 16, v17
    v_and_b32 v69, 0xffff0000, v17
    v_mul_f32 v70, 0x34e38e39, v70
    v_mul_f32 v71, 0x34e38e39, v71
    v_cvt_pk_bf16_f32 v18, v70, v71
    v_lshlrev_b32 v70, 16, v18
    v_and_b32 v71, 0xffff0000, v18
    v_mul_f32 v72, 0x34e38e39, v72
    v_mul_f32 v73, 0x34e38e39, v73
    v_cvt_pk_bf16_f32 v17, v72, v73
    v_lshlrev_b32 v72, 16, v17
    v_and_b32 v73, 0xffff0000, v17
    v_mul_f32 v74, 0x34e38e39, v74
    v_mul_f32 v75, 0x34e38e39, v75
    v_cvt_pk_bf16_f32 v18, v74, v75
    v_lshlrev_b32 v74, 16, v18
    v_and_b32 v75, 0xffff0000, v18
    v_mul_f32 v76, 0x34e38e39, v76
    v_mul_f32 v77, 0x34e38e39, v77
    v_cvt_pk_bf16_f32 v17, v76, v77
    v_lshlrev_b32 v76, 16, v17
    v_and_b32 v77, 0xffff0000, v17
    s_mul_i32 s43, s40, 4608
    v_lshlrev_b32 v10, 2, v2
    v_add_u32 v10, s43, v10
    ds_write_b32 v10, v60 offset:20736
    ds_write_b32 v10, v61 offset:23040
    ds_write_b32 v10, v62 offset:20992
    ds_write_b32 v10, v63 offset:23296
    ds_write_b32 v10, v64 offset:21248
    ds_write_b32 v10, v65 offset:23552
    ds_write_b32 v10, v66 offset:21504
    ds_write_b32 v10, v67 offset:23808
    ds_write_b32 v10, v68 offset:21760
    ds_write_b32 v10, v69 offset:24064
    ds_write_b32 v10, v70 offset:22016
    ds_write_b32 v10, v71 offset:24320
    ds_write_b32 v10, v72 offset:22272
    ds_write_b32 v10, v73 offset:24576
    ds_write_b32 v10, v74 offset:22528
    ds_write_b32 v10, v75 offset:24832
    ds_write_b32 v10, v76 offset:22784
    ds_write_b32 v10, v77 offset:25088
L_d_skip1:
    s_waitcnt lgkmcnt(0)
    s_barrier
    s_branch L_k2_end
L_d_red:
    s_cmp_lg_u32 s33, 7
    s_cbranch_scc1 L_d_red2
    s_lshl_b32 s51, s2, 7
    s_add_u32 s51, s51, 65536
    v_mov_b32 v244, 1
    v_mov_b32 v245, 0
    s_mov_b64 s[30:31], exec
    s_mov_b64 exec, 1
    buffer_store_dword v244, v245, s[56:59], s51 offen sc0 sc1
    s_mov_b64 exec, s[30:31]
L_d_red2:
    s_lshr_b32 s52, s2, 4
    v_lshrrev_b32 v240, 2, v2
    v_lshlrev_b32 v240, 1, v240
    s_lshr_b32 s53, s52, 3
    v_add_u32 v240, s53, v240
    s_and_b32 s53, s52, 7
    s_lshl_b32 s53, s53, 2
    v_and_b32 v241, 3, v2
    v_add_u32 v241, s53, v241
    v_lshlrev_b32 v241, 3, v241
    v_add_u32 v240, v240, v241
    v_lshlrev_b32 v240, 7, v240
    v_cmp_le_u32 vcc, 16, v2
    s_nop 1
    v_cndmask_b32 v242, 0, 1, vcc
    v_subrev_u32 v1, 320, v0
    s_mul_i32 s32, s2, 18432
    s_mul_i32 s34, s2, 9216
    v_lshlrev_b32 v15, 4, v1
    v_lshlrev_b32 v9, 3, v1
    s_add_u32 s35, s34, 0
    buffer_load_dwordx2 v[20:21], v9, s[12:15], s35 offen
    v_add_u32 v10, 0, v1
    v_mul_u32_u24 v10, 3641, v10
    v_lshrrev_b32 v10, 19, v10
    v_lshlrev_b32 v10, 1, v10
    s_lshl_b32 s35, s2, 4
    buffer_load_ushort v32, v10, s[16:19], s35 offen
    s_add_u32 s35, s34, 1536
    buffer_load_dwordx2 v[22:23], v9, s[12:15], s35 offen
    v_add_u32 v10, 192, v1
    v_mul_u32_u24 v10, 3641, v10
    v_lshrrev_b32 v10, 19, v10
    v_lshlrev_b32 v10, 1, v10
    s_lshl_b32 s35, s2, 4
    buffer_load_ushort v33, v10, s[16:19], s35 offen
    s_add_u32 s35, s34, 3072
    buffer_load_dwordx2 v[24:25], v9, s[12:15], s35 offen
    v_add_u32 v10, 384, v1
    v_mul_u32_u24 v10, 3641, v10
    v_lshrrev_b32 v10, 19, v10
    v_lshlrev_b32 v10, 1, v10
    s_lshl_b32 s35, s2, 4
    buffer_load_ushort v34, v10, s[16:19], s35 offen
    s_add_u32 s35, s34, 4608
    buffer_load_dwordx2 v[26:27], v9, s[12:15], s35 offen
    v_add_u32 v10, 576, v1
    v_mul_u32_u24 v10, 3641, v10
    v_lshrrev_b32 v10, 19, v10
    v_lshlrev_b32 v10, 1, v10
    s_lshl_b32 s35, s2, 4
    buffer_load_ushort v35, v10, s[16:19], s35 offen
    s_add_u32 s35, s34, 6144
    buffer_load_dwordx2 v[28:29], v9, s[12:15], s35 offen
    v_add_u32 v10, 768, v1
    v_mul_u32_u24 v10, 3641, v10
    v_lshrrev_b32 v10, 19, v10
    v_lshlrev_b32 v10, 1, v10
    s_lshl_b32 s35, s2, 4
    buffer_load_ushort v36, v10, s[16:19], s35 offen
    s_add_u32 s35, s34, 7680
    buffer_load_dwordx2 v[30:31], v9, s[12:15], s35 offen
    v_add_u32 v10, 960, v1
    v_mul_u32_u24 v10, 3641, v10
    v_lshrrev_b32 v10, 19, v10
    v_lshlrev_b32 v10, 1, v10
    s_lshl_b32 s35, s2, 4
    buffer_load_ushort v37, v10, s[16:19], s35 offen
    s_barrier
    s_barrier
    s_mov_b32 s50, 400000
    s_mov_b32 s51, 65536
L_poll_d:
    buffer_load_dword v243, v240, s[56:59], s51 offen sc0 sc1
    s_waitcnt vmcnt(0)
    v_or_b32 v243, v243, v242
    v_cmp_eq_u32 vcc, 0, v243
    s_sub_u32 s50, s50, 1
    s_cmp_eq_u32 s50, 0
    s_cbranch_scc1 L_pollx_d
    s_cmp_eq_u64 vcc, 0
    s_cbranch_scc1 L_pollx_d
    s_sleep 2
    s_branch L_poll_d
L_pollx_d:
    s_add_u32 s35, s32, 0
    buffer_load_dwordx4 v[100:103], v15, s[20:23], s35 offen
    s_add_u32 s35, s32, 4718592
    buffer_load_dwordx4 v[104:107], v15, s[20:23], s35 offen
    s_add_u32 s35, s32, 9437184
    buffer_load_dwordx4 v[108:111], v15, s[20:23], s35 offen
    s_add_u32 s35, s32, 14155776
    buffer_load_dwordx4 v[112:115], v15, s[20:23], s35 offen
    s_add_u32 s35, s32, 3072
    buffer_load_dwordx4 v[116:119], v15, s[20:23], s35 offen
    s_add_u32 s35, s32, 4721664
    buffer_load_dwordx4 v[120:123], v15, s[20:23], s35 offen
    s_add_u32 s35, s32, 9440256
    buffer_load_dwordx4 v[124:127], v15, s[20:23], s35 offen
    s_add_u32 s35, s32, 14158848
    buffer_load_dwordx4 v[128:131], v15, s[20:23], s35 offen
    s_add_u32 s35, s32, 6144
    buffer_load_dwordx4 v[132:135], v15, s[20:23], s35 offen
    s_add_u32 s35, s32, 4724736
    buffer_load_dwordx4 v[136:139], v15, s[20:23], s35 offen
    s_add_u32 s35, s32, 9443328
    buffer_load_dwordx4 v[140:143], v15, s[20:23], s35 offen
    s_add_u32 s35, s32, 14161920
    buffer_load_dwordx4 v[144:147], v15, s[20:23], s35 offen
    s_add_u32 s35, s32, 9216
    buffer_load_dwordx4 v[148:151], v15, s[20:23], s35 offen
    s_add_u32 s35, s32, 4727808
    buffer_load_dwordx4 v[152:155], v15, s[20:23], s35 offen
    s_add_u32 s35, s32, 9446400
    buffer_load_dwordx4 v[156:159], v15, s[20:23], s35 offen
    s_add_u32 s35, s32, 14164992
    buffer_load_dwordx4 v[160:163], v15, s[20:23], s35 offen
    s_add_u32 s35, s32, 12288
    buffer_load_dwordx4 v[164:167], v15, s[20:23], s35 offen
    s_add_u32 s35, s32, 4730880
    buffer_load_dwordx4 v[168:171], v15, s[20:23], s35 offen
    s_add_u32 s35, s32, 9449472
    buffer_load_dwordx4 v[172:175], v15, s[20:23], s35 offen
    s_add_u32 s35, s32, 14168064
    buffer_load_dwordx4 v[176:179], v15, s[20:23], s35 offen
    s_add_u32 s35, s32, 15360
    buffer_load_dwordx4 v[180:183], v15, s[20:23], s35 offen
    s_add_u32 s35, s32, 4733952
    buffer_load_dwordx4 v[184:187], v15, s[20:23], s35 offen
    s_add_u32 s35, s32, 9452544
    buffer_load_dwordx4 v[188:191], v15, s[20:23], s35 offen
    s_add_u32 s35, s32, 14171136
    buffer_load_dwordx4 v[192:195], v15, s[20:23], s35 offen
    s_waitcnt vmcnt(0)
    v_add_f32 v100, v100, v104
    v_add_f32 v108, v108, v112
    v_add_f32 v100, v100, v108
    v_add_f32 v101, v101, v105
    v_add_f32 v109, v109, v113
    v_add_f32 v101, v101, v109
    v_add_f32 v102, v102, v106
    v_add_f32 v110, v110, v114
    v_add_f32 v102, v102, v110
    v_add_f32 v103, v103, v107
    v_add_f32 v111, v111, v115
    v_add_f32 v103, v103, v111
    v_lshlrev_b32 v32, 16, v32
    v_cvt_pk_bf16_f32 v4, v100, v101
    v_lshlrev_b32 v100, 16, v4
    v_and_b32 v101, 0xffff0000, v4
    v_cvt_pk_bf16_f32 v5, v102, v103
    v_lshlrev_b32 v102, 16, v5
    v_and_b32 v103, 0xffff0000, v5
    v_add_f32 v100, v100, v32
    v_add_f32 v101, v101, v32
    v_add_f32 v102, v102, v32
    v_add_f32 v103, v103, v32
    v_cvt_pk_bf16_f32 v4, v100, v101
    v_lshlrev_b32 v100, 16, v4
    v_and_b32 v101, 0xffff0000, v4
    v_cvt_pk_bf16_f32 v5, v102, v103
    v_lshlrev_b32 v102, 16, v5
    v_and_b32 v103, 0xffff0000, v5
    v_lshlrev_b32 v104, 16, v20
    v_and_b32 v105, 0xffff0000, v20
    v_lshlrev_b32 v106, 16, v21
    v_and_b32 v107, 0xffff0000, v21
    v_add_f32 v116, v116, v120
    v_add_f32 v124, v124, v128
    v_add_f32 v116, v116, v124
    v_add_f32 v117, v117, v121
    v_add_f32 v125, v125, v129
    v_add_f32 v117, v117, v125
    v_add_f32 v118, v118, v122
    v_add_f32 v126, v126, v130
    v_add_f32 v118, v118, v126
    v_add_f32 v119, v119, v123
    v_add_f32 v127, v127, v131
    v_add_f32 v119, v119, v127
    v_lshlrev_b32 v33, 16, v33
    v_cvt_pk_bf16_f32 v4, v116, v117
    v_lshlrev_b32 v116, 16, v4
    v_and_b32 v117, 0xffff0000, v4
    v_cvt_pk_bf16_f32 v5, v118, v119
    v_lshlrev_b32 v118, 16, v5
    v_and_b32 v119, 0xffff0000, v5
    v_add_f32 v116, v116, v33
    v_add_f32 v117, v117, v33
    v_add_f32 v118, v118, v33
    v_add_f32 v119, v119, v33
    v_cvt_pk_bf16_f32 v4, v116, v117
    v_lshlrev_b32 v116, 16, v4
    v_and_b32 v117, 0xffff0000, v4
    v_cvt_pk_bf16_f32 v5, v118, v119
    v_lshlrev_b32 v118, 16, v5
    v_and_b32 v119, 0xffff0000, v5
    v_lshlrev_b32 v120, 16, v22
    v_and_b32 v121, 0xffff0000, v22
    v_lshlrev_b32 v122, 16, v23
    v_and_b32 v123, 0xffff0000, v23
    v_add_f32 v132, v132, v136
    v_add_f32 v140, v140, v144
    v_add_f32 v132, v132, v140
    v_add_f32 v133, v133, v137
    v_add_f32 v141, v141, v145
    v_add_f32 v133, v133, v141
    v_add_f32 v134, v134, v138
    v_add_f32 v142, v142, v146
    v_add_f32 v134, v134, v142
    v_add_f32 v135, v135, v139
    v_add_f32 v143, v143, v147
    v_add_f32 v135, v135, v143
    v_lshlrev_b32 v34, 16, v34
    v_cvt_pk_bf16_f32 v4, v132, v133
    v_lshlrev_b32 v132, 16, v4
    v_and_b32 v133, 0xffff0000, v4
    v_cvt_pk_bf16_f32 v5, v134, v135
    v_lshlrev_b32 v134, 16, v5
    v_and_b32 v135, 0xffff0000, v5
    v_add_f32 v132, v132, v34
    v_add_f32 v133, v133, v34
    v_add_f32 v134, v134, v34
    v_add_f32 v135, v135, v34
    v_cvt_pk_bf16_f32 v4, v132, v133
    v_lshlrev_b32 v132, 16, v4
    v_and_b32 v133, 0xffff0000, v4
    v_cvt_pk_bf16_f32 v5, v134, v135
    v_lshlrev_b32 v134, 16, v5
    v_and_b32 v135, 0xffff0000, v5
    v_lshlrev_b32 v136, 16, v24
    v_and_b32 v137, 0xffff0000, v24
    v_lshlrev_b32 v138, 16, v25
    v_and_b32 v139, 0xffff0000, v25
    v_add_f32 v148, v148, v152
    v_add_f32 v156, v156, v160
    v_add_f32 v148, v148, v156
    v_add_f32 v149, v149, v153
    v_add_f32 v157, v157, v161
    v_add_f32 v149, v149, v157
    v_add_f32 v150, v150, v154
    v_add_f32 v158, v158, v162
    v_add_f32 v150, v150, v158
    v_add_f32 v151, v151, v155
    v_add_f32 v159, v159, v163
    v_add_f32 v151, v151, v159
    v_lshlrev_b32 v35, 16, v35
    v_cvt_pk_bf16_f32 v4, v148, v149
    v_lshlrev_b32 v148, 16, v4
    v_and_b32 v149, 0xffff0000, v4
    v_cvt_pk_bf16_f32 v5, v150, v151
    v_lshlrev_b32 v150, 16, v5
    v_and_b32 v151, 0xffff0000, v5
    v_add_f32 v148, v148, v35
    v_add_f32 v149, v149, v35
    v_add_f32 v150, v150, v35
    v_add_f32 v151, v151, v35
    v_cvt_pk_bf16_f32 v4, v148, v149
    v_lshlrev_b32 v148, 16, v4
    v_and_b32 v149, 0xffff0000, v4
    v_cvt_pk_bf16_f32 v5, v150, v151
    v_lshlrev_b32 v150, 16, v5
    v_and_b32 v151, 0xffff0000, v5
    v_lshlrev_b32 v152, 16, v26
    v_and_b32 v153, 0xffff0000, v26
    v_lshlrev_b32 v154, 16, v27
    v_and_b32 v155, 0xffff0000, v27
    v_add_f32 v164, v164, v168
    v_add_f32 v172, v172, v176
    v_add_f32 v164, v164, v172
    v_add_f32 v165, v165, v169
    v_add_f32 v173, v173, v177
    v_add_f32 v165, v165, v173
    v_add_f32 v166, v166, v170
    v_add_f32 v174, v174, v178
    v_add_f32 v166, v166, v174
    v_add_f32 v167, v167, v171
    v_add_f32 v175, v175, v179
    v_add_f32 v167, v167, v175
    v_lshlrev_b32 v36, 16, v36
    v_cvt_pk_bf16_f32 v4, v164, v165
    v_lshlrev_b32 v164, 16, v4
    v_and_b32 v165, 0xffff0000, v4
    v_cvt_pk_bf16_f32 v5, v166, v167
    v_lshlrev_b32 v166, 16, v5
    v_and_b32 v167, 0xffff0000, v5
    v_add_f32 v164, v164, v36
    v_add_f32 v165, v165, v36
    v_add_f32 v166, v166, v36
    v_add_f32 v167, v167, v36
    v_cvt_pk_bf16_f32 v4, v164, v165
    v_lshlrev_b32 v164, 16, v4
    v_and_b32 v165, 0xffff0000, v4
    v_cvt_pk_bf16_f32 v5, v166, v167
    v_lshlrev_b32 v166, 16, v5
    v_and_b32 v167, 0xffff0000, v5
    v_lshlrev_b32 v168, 16, v28
    v_and_b32 v169, 0xffff0000, v28
    v_lshlrev_b32 v170, 16, v29
    v_and_b32 v171, 0xffff0000, v29
    v_add_f32 v180, v180, v184
    v_add_f32 v188, v188, v192
    v_add_f32 v180, v180, v188
    v_add_f32 v181, v181, v185
    v_add_f32 v189, v189, v193
    v_add_f32 v181, v181, v189
    v_add_f32 v182, v182, v186
    v_add_f32 v190, v190, v194
    v_add_f32 v182, v182, v190
    v_add_f32 v183, v183, v187
    v_add_f32 v191, v191, v195
    v_add_f32 v183, v183, v191
    v_lshlrev_b32 v37, 16, v37
    v_cvt_pk_bf16_f32 v4, v180, v181
    v_lshlrev_b32 v180, 16, v4
    v_and_b32 v181, 0xffff0000, v4
    v_cvt_pk_bf16_f32 v5, v182, v183
    v_lshlrev_b32 v182, 16, v5
    v_and_b32 v183, 0xffff0000, v5
    v_add_f32 v180, v180, v37
    v_add_f32 v181, v181, v37
    v_add_f32 v182, v182, v37
    v_add_f32 v183, v183, v37
    v_cvt_pk_bf16_f32 v4, v180, v181
    v_lshlrev_b32 v180, 16, v4
    v_and_b32 v181, 0xffff0000, v4
    v_cvt_pk_bf16_f32 v5, v182, v183
    v_lshlrev_b32 v182, 16, v5
    v_and_b32 v183, 0xffff0000, v5
    v_lshlrev_b32 v184, 16, v30
    v_and_b32 v185, 0xffff0000, v30
    v_lshlrev_b32 v186, 16, v31
    v_and_b32 v187, 0xffff0000, v31
    s_barrier
    ds_read_b128 v[40:43], v15 offset:20736
    ds_read_b128 v[44:47], v15 offset:23808
    ds_read_b128 v[48:51], v15 offset:26880
    ds_read_b128 v[52:55], v15 offset:29952
    ds_read_b128 v[56:59], v15 offset:33024
    ds_read_b128 v[60:63], v15 offset:36096
    s_waitcnt lgkmcnt(0)
    v_add_f32 v104, v104, v40
    v_add_f32 v105, v105, v41
    v_add_f32 v106, v106, v42
    v_add_f32 v107, v107, v43
    v_cvt_pk_bf16_f32 v4, v104, v105
    v_lshlrev_b32 v104, 16, v4
    v_and_b32 v105, 0xffff0000, v4
    v_cvt_pk_bf16_f32 v5, v106, v107
    v_lshlrev_b32 v106, 16, v5
    v_and_b32 v107, 0xffff0000, v5
    v_add_f32 v100, v100, v104
    v_add_f32 v101, v101, v105
    v_add_f32 v102, v102, v106
    v_add_f32 v103, v103, v107
    v_cvt_pk_bf16_f32 v108, v100, v101
    v_cvt_pk_bf16_f32 v109, v102, v103
    s_add_u32 s35, s34, 0
    buffer_store_dwordx2 v[108:109], v9, s[24:27], s35 offen
    v_add_f32 v120, v120, v44
    v_add_f32 v121, v121, v45
    v_add_f32 v122, v122, v46
    v_add_f32 v123, v123, v47
    v_cvt_pk_bf16_f32 v4, v120, v121
    v_lshlrev_b32 v120, 16, v4
    v_and_b32 v121, 0xffff0000, v4
    v_cvt_pk_bf16_f32 v5, v122, v123
    v_lshlrev_b32 v122, 16, v5
    v_and_b32 v123, 0xffff0000, v5
    v_add_f32 v116, v116, v120
    v_add_f32 v117, v117, v121
    v_add_f32 v118, v118, v122
    v_add_f32 v119, v119, v123
    v_cvt_pk_bf16_f32 v124, v116, v117
    v_cvt_pk_bf16_f32 v125, v118, v119
    s_add_u32 s35, s34, 1536
    buffer_store_dwordx2 v[124:125], v9, s[24:27], s35 offen
    v_add_f32 v136, v136, v48
    v_add_f32 v137, v137, v49
    v_add_f32 v138, v138, v50
    v_add_f32 v139, v139, v51
    v_cvt_pk_bf16_f32 v4, v136, v137
    v_lshlrev_b32 v136, 16, v4
    v_and_b32 v137, 0xffff0000, v4
    v_cvt_pk_bf16_f32 v5, v138, v139
    v_lshlrev_b32 v138, 16, v5
    v_and_b32 v139, 0xffff0000, v5
    v_add_f32 v132, v132, v136
    v_add_f32 v133, v133, v137
    v_add_f32 v134, v134, v138
    v_add_f32 v135, v135, v139
    v_cvt_pk_bf16_f32 v140, v132, v133
    v_cvt_pk_bf16_f32 v141, v134, v135
    s_add_u32 s35, s34, 3072
    buffer_store_dwordx2 v[140:141], v9, s[24:27], s35 offen
    v_add_f32 v152, v152, v52
    v_add_f32 v153, v153, v53
    v_add_f32 v154, v154, v54
    v_add_f32 v155, v155, v55
    v_cvt_pk_bf16_f32 v4, v152, v153
    v_lshlrev_b32 v152, 16, v4
    v_and_b32 v153, 0xffff0000, v4
    v_cvt_pk_bf16_f32 v5, v154, v155
    v_lshlrev_b32 v154, 16, v5
    v_and_b32 v155, 0xffff0000, v5
    v_add_f32 v148, v148, v152
    v_add_f32 v149, v149, v153
    v_add_f32 v150, v150, v154
    v_add_f32 v151, v151, v155
    v_cvt_pk_bf16_f32 v156, v148, v149
    v_cvt_pk_bf16_f32 v157, v150, v151
    s_add_u32 s35, s34, 4608
    buffer_store_dwordx2 v[156:157], v9, s[24:27], s35 offen
    v_add_f32 v168, v168, v56
    v_add_f32 v169, v169, v57
    v_add_f32 v170, v170, v58
    v_add_f32 v171, v171, v59
    v_cvt_pk_bf16_f32 v4, v168, v169
    v_lshlrev_b32 v168, 16, v4
    v_and_b32 v169, 0xffff0000, v4
    v_cvt_pk_bf16_f32 v5, v170, v171
    v_lshlrev_b32 v170, 16, v5
    v_and_b32 v171, 0xffff0000, v5
    v_add_f32 v164, v164, v168
    v_add_f32 v165, v165, v169
    v_add_f32 v166, v166, v170
    v_add_f32 v167, v167, v171
    v_cvt_pk_bf16_f32 v172, v164, v165
    v_cvt_pk_bf16_f32 v173, v166, v167
    s_add_u32 s35, s34, 6144
    buffer_store_dwordx2 v[172:173], v9, s[24:27], s35 offen
    v_add_f32 v184, v184, v60
    v_add_f32 v185, v185, v61
    v_add_f32 v186, v186, v62
    v_add_f32 v187, v187, v63
    v_cvt_pk_bf16_f32 v4, v184, v185
    v_lshlrev_b32 v184, 16, v4
    v_and_b32 v185, 0xffff0000, v4
    v_cvt_pk_bf16_f32 v5, v186, v187
    v_lshlrev_b32 v186, 16, v5
    v_and_b32 v187, 0xffff0000, v5
    v_add_f32 v180, v180, v184
    v_add_f32 v181, v181, v185
    v_add_f32 v182, v182, v186
    v_add_f32 v183, v183, v187
    v_cvt_pk_bf16_f32 v188, v180, v181
    v_cvt_pk_bf16_f32 v189, v182, v183
    s_add_u32 s35, s34, 7680
    buffer_store_dwordx2 v[188:189], v9, s[24:27], s35 offen
L_k2_end:
    s_endpgm
.section .rodata,"a"
.p2align 6
.amdhsa_kernel parallel_sum__spectral_gfnet__mixer_token_mlp__prompt_kernel
  .amdhsa_next_free_vgpr 256
  .amdhsa_next_free_sgpr 102
  .amdhsa_accum_offset 256
  .amdhsa_group_segment_fixed_size 0
  .amdhsa_float_denorm_mode_32 3
  .amdhsa_kernarg_size 88
  .amdhsa_user_sgpr_count 2
  .amdhsa_user_sgpr_kernarg_segment_ptr 1
  .amdhsa_system_sgpr_workgroup_id_x 1
.end_amdhsa_kernel
```
